```python
import torch

def _softmax(x, axis=-1):
    return torch.softmax(x, dim=axis)

def _gelu(x):
    return torch.nn.functional.gelu(x, approximate='tanh')

def _silu(x):
    return torch.nn.functional.silu(x)

def _sigmoid(x):
    return torch.sigmoid(x)

def _layernorm(x, axis=-1, eps=1e-05):
    m = x.mean(dim=axis, keepdim=True)
    v = x.var(dim=axis, keepdim=True, unbiased=False)
    return (x - m) / torch.sqrt(v + eps)

def _scatter_add(tgt, idx, src, axis=0):
    return tgt.clone().index_add_(axis, idx, src)

def _segment_sum(src, seg, n):
    out = torch.zeros((n,) + src.shape[1:], dtype=src.dtype)
    return out.index_add_(0, seg, src)

def _pad(x, pw):
    flat = tuple((v for pair in reversed(pw) for v in pair))
    return torch.nn.functional.pad(x, flat)
kernel_name = 'standalone__video_timesformer__vision'

def setup_inputs():

    _w = lambda a: (lambda t: t.to(torch.bfloat16) if t.is_floating_point() else t)(torch.as_tensor(a))
    T = 8
    p = 14
    HW = 384 // p * p
    N = (HW // p) ** 2
    C = 192
    return {'x': _w((lambda *s: torch.randn(*s, dtype=torch.bfloat16) * 0.05)(1, T, N, C)), 'wqkv_t': _w((lambda *s: torch.randn(*s, dtype=torch.bfloat16) * 0.05)(C, 3 * C)), 'wo_t': _w((lambda *s: torch.randn(*s, dtype=torch.bfloat16) * 0.05)(C, C)), 'wqkv_s': _w((lambda *s: torch.randn(*s, dtype=torch.bfloat16) * 0.05)(C, 3 * C)), 'wo_s': _w((lambda *s: torch.randn(*s, dtype=torch.bfloat16) * 0.4)(C, C))}

def reference(x, wqkv_t, wo_t, wqkv_s, wo_s):
    B, T, N, C = x.shape
    scale = C ** (-0.5)
    xt = (lambda x, *d: x.permute(*d))(x, 0, 2, 1, 3).reshape(B * N, T, C)
    h = _layernorm(xt, axis=-1)
    qkv = h @ wqkv_t
    q, k, v = (qkv[..., :C].clone(), qkv[..., C:2 * C].clone(), qkv[..., 2 * C:].clone())
    a = _softmax(torch.einsum('btc,bsc->bts', q, k) * scale, axis=-1)
    xt = xt + torch.einsum('bts,bsc->btc', a, v) @ wo_t
    x1 = (lambda x, *d: x.permute(*d))(xt.reshape(B, N, T, C), 0, 2, 1, 3)
    xs = x1.reshape(B * T, N, C)
    h = _layernorm(xs, axis=-1)
    qkv = h @ wqkv_s
    q, k, v = (qkv[..., :C].clone(), qkv[..., C:2 * C].clone(), qkv[..., 2 * C:].clone())
    a = _softmax(torch.einsum('bnc,bmc->bnm', q, k) * scale, axis=-1)
    xs = xs + torch.einsum('bnm,bmc->bnc', a, v) @ wo_s
    return xs.reshape(B, T, N, C)
```

```asm
; @launch grid=(256,1,1) block=(256,1,1) lds=160768
.amdgcn_target "amdgcn-amd-amdhsa--gfx950"
.text
.globl standalone__video_timesformer__vision_kernel
.p2align 8
.type standalone__video_timesformer__vision_kernel,@function
standalone__video_timesformer__vision_kernel:
  s_load_dwordx2 s[4:5], s[0:1], 0
  s_load_dwordx2 s[8:9], s[0:1], 8
  s_load_dwordx2 s[12:13], s[0:1], 16
  s_cmp_ge_u32 s2, 256
  s_cbranch_scc1 L_end
  s_lshr_b32 s3, s2, 3
  s_and_b32 s30, s2, 7
  s_cmp_lt_u32 s3, 9
  s_cbranch_scc1 L_fusion
  v_lshrrev_b32 v100, 6, v0
  v_and_b32 v1, 63, v0
  s_sub_u32 s29, s3, 9
  v_readfirstlane_b32 s28, v100
  s_lshl_b32 s31, s29, 5
  s_lshl_b32 s34, s30, 2
  s_add_u32 s31, s31, s34
  v_lshrrev_b32 v100, 3, v1
  v_and_b32_e64 v101, 7, v1
  s_add_u32 s31, s31, s28
  s_mul_i32 s34, s31, 384
  s_cmp_ge_u32 s31, 729
  s_cselect_b32 s34, 0x40000000, s34
  v_mul_u32_u24 v102, 279936, v100
  v_lshl_add_u32 v102, v101, 4, v102
  v_add_u32 v2, s34, v102
  s_mov_b32 s6, 0x00222c00
  s_mov_b32 s7, 0x20000
  s_waitcnt lgkmcnt(0)
  buffer_load_dwordx4 v[64:67], v2, s[4:7], 0 offen offset:0
  buffer_load_dwordx4 v[68:71], v2, s[4:7], 0 offen offset:128
  buffer_load_dwordx4 v[72:75], v2, s[4:7], 0 offen offset:256
  s_load_dwordx2 s[16:17], s[0:1], 56
  s_load_dwordx2 s[24:25], s[0:1], 48
  s_load_dwordx2 s[20:21], s[0:1], 40
  s_mov_b32 s10, 0x00036000
  s_mov_b32 s11, 0x20000
  s_mov_b32 s14, 0x00012000
  s_mov_b32 s15, 0x20000
  s_mov_b32 s37, 1152
  s_mov_b32 s38, 384
  s_mul_i32 s35, s28, 96
  s_mul_i32 s40, s28, 27648
  v_lshlrev_b32 v17, 4, v1
  s_movk_i32 s36, -96
  v_add_u32 v104, s35, v17
  v_mul_u32_u24 v101, 171, v1
  v_lshrrev_b32 v101, 10, v101
  v_and_b32 v102, 12, v101
  v_lshrrev_b32 v103, 4, v101
  v_add_u32 v102, v102, v101
  v_mad_i32_i24 v100, v101, s36, v104
  v_mad_i32_i24 v102, v103, -12, v102
  v_mad_u32_u24 v3, v102, s37, v100
  v_mad_u32_u24 v6, v102, s38, v100
  v_add_u32_e64 v100, 64, v1
  v_mul_u32_u24 v101, 171, v100
  v_lshrrev_b32 v101, 10, v101
  v_and_b32 v102, 12, v101
  v_lshrrev_b32 v103, 4, v101
  v_add_u32 v102, v102, v101
  v_mad_i32_i24 v100, v101, s36, v104
  v_mad_i32_i24 v102, v103, -12, v102
  v_mad_u32_u24 v4, v102, s37, v100
  v_mad_u32_u24 v7, v102, s38, v100
  v_add_u32 v100, 128, v1
  v_mul_u32_u24 v101, 171, v100
  v_lshrrev_b32 v101, 10, v101
  v_and_b32 v102, 12, v101
  v_lshrrev_b32 v103, 4, v101
  v_add_u32 v102, v102, v101
  v_mad_i32_i24 v100, v101, s36, v104
  v_mad_i32_i24 v102, v103, -12, v102
  v_mad_u32_u24 v5, v102, s37, v100
  v_mad_u32_u24 v8, v102, s38, v100
  s_add_u32 m0, s40, 0
  s_mov_b32 s39, 0
  buffer_load_dwordx4 v3, s[8:11], s39 offen offset:0 lds
  buffer_load_dwordx4 v4, s[8:11], s39 offen offset:1024 lds
  buffer_load_dwordx4 v5, s[8:11], s39 offen offset:2048 lds
  s_add_u32 m0, s40, 3072
  s_mov_b32 s39, 36864
  buffer_load_dwordx4 v3, s[8:11], s39 offen offset:0 lds
  buffer_load_dwordx4 v4, s[8:11], s39 offen offset:1024 lds
  buffer_load_dwordx4 v5, s[8:11], s39 offen offset:2048 lds
  v_lshrrev_b32 v100, 2, v1
  v_and_b32 v101, 3, v1
  v_mul_u32_u24 v100, 96, v100
  v_lshl_add_u32 v100, v101, 3, v100
  v_add_u32 v9, s40, v100
  v_lshrrev_b32 v100, 3, v1
  v_and_b32_e64 v101, 7, v1
  v_lshl_add_u32 v100, s28, 3, v100
  v_xor_b32 v100, v100, v101
  v_lshlrev_b32 v100, 4, v100
  v_lshl_add_u32 v100, v101, 9, v100
  v_add_u32 v15, 110592, v100
  v_and_b32 v105, 15, v1
  v_lshrrev_b32 v106, 4, v1
  v_xor_b32 v100, v105, v106
  v_lshlrev_b32 v102, 9, v106
  v_xor_b32_e64 v101, 4, v100
  v_add_u32 v102, 110592, v102
  v_lshl_add_u32 v10, v100, 4, v102
  v_lshl_add_u32 v11, v101, 4, v102
  s_mov_b32 s18, 0x00500000
  s_mov_b32 s19, 0x20000
  s_mov_b32 s26, 0x00000100
  s_mov_b32 s27, 0x20000
  s_mov_b32 s22, 0x00222c00
  s_mov_b32 s23, 0x20000
  s_add_u32 m0, s40, 6144
  s_mov_b32 s39, 73728
  buffer_load_dwordx4 v3, s[8:11], s39 offen offset:0 lds
  buffer_load_dwordx4 v4, s[8:11], s39 offen offset:1024 lds
  buffer_load_dwordx4 v5, s[8:11], s39 offen offset:2048 lds
  v_and_b32 v201, 15, v1
  v_lshrrev_b32 v202, 4, v1
  s_mul_i32 s31, s28, 6
  v_lshrrev_b32 v196, 1, v202
  v_add_u32 v197, s31, v196
  v_and_b32 v198, 1, v202
  v_lshlrev_b32_e64 v199, 3, v198
  v_add_u32 v199, 122880, v199
  v_add_u32 v200, 0, v197
  v_and_b32 v12, 7, v200
  v_xor_b32 v12, v12, v201
  v_lshlrev_b32 v12, 4, v12
  v_lshl_add_u32 v12, v200, 9, v12
  v_add_u32 v12, v12, v199
  v_add_u32 v200, 2, v197
  v_and_b32 v13, 7, v200
  v_xor_b32 v13, v13, v201
  v_lshlrev_b32_e64 v13, 4, v13
  v_lshl_add_u32 v13, v200, 9, v13
  v_add_u32 v13, v13, v199
  v_add_u32 v200, 4, v197
  v_and_b32 v14, 7, v200
  v_xor_b32 v14, v14, v201
  v_lshlrev_b32_e64 v14, 4, v14
  v_lshl_add_u32 v14, v200, 9, v14
  v_add_u32 v14, v14, v199
  v_lshrrev_b32 v197, 3, v201
  v_cmp_eq_u32 s[42:43], v196, v197
  s_mul_i32 s35, s29, 12288
  s_mul_i32 s31, s28, 3
  s_and_b32 s34, s31, 1
  s_xor_b32 s34, s34, s30
  s_lshl_b32 s34, s34, 7
  s_lshl_b32 s55, s31, 10
  s_add_u32 s55, s55, s34
  s_add_u32 s55, s55, s35
  s_add_u32 s31, s31, 1
  s_and_b32 s34, s31, 1
  s_xor_b32 s34, s34, s30
  s_lshl_b32 s34, s34, 7
  s_lshl_b32 s56, s31, 10
  s_add_u32 s56, s56, s34
  s_add_u32 s56, s56, s35
  s_add_u32 s31, s31, 1
  s_and_b32 s34, s31, 1
  s_xor_b32 s34, s34, s30
  s_lshl_b32 s34, s34, 7
  s_lshl_b32 s57, s31, 10
  s_add_u32 s57, s57, s34
  s_add_u32 s57, s57, s35
  s_waitcnt lgkmcnt(0)
  s_waitcnt vmcnt(9)
  v_lshlrev_b32 v76, 16, v64
  v_and_b32 v77, 0xffff0000, v64
  v_lshlrev_b32_e64 v78, 16, v65
  v_and_b32 v79, 0xffff0000, v65
  v_lshlrev_b32_e64 v80, 16, v66
  v_and_b32 v81, 0xffff0000, v66
  v_lshlrev_b32_e64 v82, 16, v67
  v_and_b32 v83, 0xffff0000, v67
  v_lshlrev_b32_e64 v84, 16, v68
  v_and_b32 v85, 0xffff0000, v68
  v_lshlrev_b32_e64 v86, 16, v69
  v_and_b32 v87, 0xffff0000, v69
  v_lshlrev_b32_e64 v88, 16, v70
  v_and_b32 v89, 0xffff0000, v70
  v_lshlrev_b32_e64 v90, 16, v71
  s_add_u32 m0, s40, 9216
  s_mov_b32 s39, 110592
  buffer_load_dwordx4 v3, s[8:11], s39 offen offset:0 lds
  v_and_b32 v91, 0xffff0000, v71
  v_lshlrev_b32_e64 v92, 16, v72
  v_and_b32 v93, 0xffff0000, v72
  v_lshlrev_b32_e64 v94, 16, v73
  v_and_b32 v95, 0xffff0000, v73
  v_lshlrev_b32_e64 v96, 16, v74
  v_and_b32 v97, 0xffff0000, v74
  v_lshlrev_b32_e64 v98, 16, v75
  v_and_b32 v99, 0xffff0000, v75
  v_pk_add_f32 v[100:101], v[76:77], v[78:79]
  v_pk_mul_f32 v[102:103], v[76:77], v[76:77]
  v_pk_fma_f32 v[102:103], v[78:79], v[78:79], v[102:103]
  v_pk_add_f32 v[100:101], v[100:101], v[80:81]
  v_pk_fma_f32 v[102:103], v[80:81], v[80:81], v[102:103]
  v_pk_add_f32 v[100:101], v[100:101], v[82:83]
  buffer_load_dwordx4 v4, s[8:11], s39 offen offset:1024 lds
  v_pk_fma_f32 v[102:103], v[82:83], v[82:83], v[102:103]
  v_pk_add_f32 v[100:101], v[100:101], v[84:85]
  v_pk_fma_f32 v[102:103], v[84:85], v[84:85], v[102:103]
  v_pk_add_f32 v[100:101], v[100:101], v[86:87]
  v_pk_fma_f32 v[102:103], v[86:87], v[86:87], v[102:103]
  v_pk_add_f32 v[100:101], v[100:101], v[88:89]
  v_pk_fma_f32 v[102:103], v[88:89], v[88:89], v[102:103]
  v_pk_add_f32 v[100:101], v[100:101], v[90:91]
  v_pk_fma_f32 v[102:103], v[90:91], v[90:91], v[102:103]
  v_pk_add_f32 v[100:101], v[100:101], v[92:93]
  v_pk_fma_f32 v[102:103], v[92:93], v[92:93], v[102:103]
  v_pk_add_f32 v[100:101], v[100:101], v[94:95]
  v_pk_fma_f32 v[102:103], v[94:95], v[94:95], v[102:103]
  v_pk_add_f32 v[100:101], v[100:101], v[96:97]
  v_pk_fma_f32 v[102:103], v[96:97], v[96:97], v[102:103]
  buffer_load_dwordx4 v5, s[8:11], s39 offen offset:2048 lds
  v_pk_add_f32 v[100:101], v[100:101], v[98:99]
  v_pk_fma_f32 v[102:103], v[98:99], v[98:99], v[102:103]
  v_add_f32 v100, v100, v101
  v_add_f32 v102, v102, v103
  s_mov_b32 s61, 0x3baaaaab
  s_nop 0
  v_add_f32_dpp v100, v100, v100 quad_perm:[1,0,3,2] row_mask:0xf bank_mask:0xf
  v_add_f32_dpp v102, v102, v102 quad_perm:[1,0,3,2] row_mask:0xf bank_mask:0xf
  s_nop 0
  v_add_f32_dpp v100, v100, v100 quad_perm:[2,3,0,1] row_mask:0xf bank_mask:0xf
  v_add_f32_dpp v102, v102, v102 quad_perm:[2,3,0,1] row_mask:0xf bank_mask:0xf
  s_nop 0
  v_add_f32_dpp v100, v100, v100 row_half_mirror row_mask:0xf bank_mask:0xf
  v_add_f32_dpp v102, v102, v102 row_half_mirror row_mask:0xf bank_mask:0xf
  s_mov_b32 s62, 0x3727c5ac
  v_mul_f32 v100, s61, v100
  s_add_u32 m0, s40, 12288
  s_mov_b32 s39, 147456
  buffer_load_dwordx4 v3, s[8:11], s39 offen offset:0 lds
  v_mov_b32 v101, s62
  v_fmac_f32 v101, s61, v102
  v_fma_f32 v101, -v100, v100, v101
  v_max_f32 v101, s62, v101
  v_rsq_f32 v102, v101
  s_nop 0
  v_mul_f32 v100, v100, v102
  v_mov_b32 v103, v102
  v_mov_b32 v101, v100
  v_pk_fma_f32 v[76:77], v[76:77], v[102:103], v[100:101] neg_lo:[0,0,1] neg_hi:[0,0,1]
  v_pk_fma_f32 v[78:79], v[78:79], v[102:103], v[100:101] neg_lo:[0,0,1] neg_hi:[0,0,1]
  v_pk_fma_f32 v[80:81], v[80:81], v[102:103], v[100:101] neg_lo:[0,0,1] neg_hi:[0,0,1]
  v_pk_fma_f32 v[82:83], v[82:83], v[102:103], v[100:101] neg_lo:[0,0,1] neg_hi:[0,0,1]
  v_pk_fma_f32 v[84:85], v[84:85], v[102:103], v[100:101] neg_lo:[0,0,1] neg_hi:[0,0,1]
  v_pk_fma_f32 v[86:87], v[86:87], v[102:103], v[100:101] neg_lo:[0,0,1] neg_hi:[0,0,1]
  buffer_load_dwordx4 v4, s[8:11], s39 offen offset:1024 lds
  v_pk_fma_f32 v[88:89], v[88:89], v[102:103], v[100:101] neg_lo:[0,0,1] neg_hi:[0,0,1]
  v_pk_fma_f32 v[90:91], v[90:91], v[102:103], v[100:101] neg_lo:[0,0,1] neg_hi:[0,0,1]
  v_pk_fma_f32 v[92:93], v[92:93], v[102:103], v[100:101] neg_lo:[0,0,1] neg_hi:[0,0,1]
  v_pk_fma_f32 v[94:95], v[94:95], v[102:103], v[100:101] neg_lo:[0,0,1] neg_hi:[0,0,1]
  v_pk_fma_f32 v[96:97], v[96:97], v[102:103], v[100:101] neg_lo:[0,0,1] neg_hi:[0,0,1]
  v_pk_fma_f32 v[98:99], v[98:99], v[102:103], v[100:101] neg_lo:[0,0,1] neg_hi:[0,0,1]
  v_cvt_pk_bf16_f32 v76, v76, v77
  v_cvt_pk_bf16_f32 v77, v78, v79
  v_cvt_pk_bf16_f32 v78, v80, v81
  v_cvt_pk_bf16_f32 v79, v82, v83
  ds_write_b128 v15, v[76:79] offset:0
  ds_write_b128 v15, v[64:67] offset:12288
  v_cvt_pk_bf16_f32 v80, v84, v85
  v_cvt_pk_bf16_f32 v81, v86, v87
  v_cvt_pk_bf16_f32 v82, v88, v89
  buffer_load_dwordx4 v5, s[8:11], s39 offen offset:2048 lds
  v_cvt_pk_bf16_f32 v83, v90, v91
  ds_write_b128 v15, v[80:83] offset:4096
  ds_write_b128 v15, v[68:71] offset:16384
  v_cvt_pk_bf16_f32 v84, v92, v93
  v_cvt_pk_bf16_f32 v85, v94, v95
  v_cvt_pk_bf16_f32 v86, v96, v97
  v_cvt_pk_bf16_f32 v87, v98, v99
  ds_write_b128 v15, v[84:87] offset:8192
  ds_write_b128 v15, v[72:75] offset:20480
  s_waitcnt lgkmcnt(0)
  s_barrier
  ds_read_b128 a[0:3], v10 offset:0
  ds_read_b128 a[24:27], v10 offset:256
  ds_read_b128 a[4:7], v11 offset:2048
  ds_read_b128 a[28:31], v11 offset:2304
  s_add_u32 m0, s40, 15360
  s_mov_b32 s39, 184320
  buffer_load_dwordx4 v3, s[8:11], s39 offen offset:0 lds
  ds_read_b128 a[8:11], v10 offset:4096
  ds_read_b128 a[32:35], v10 offset:4352
  ds_read_b128 a[12:15], v11 offset:6144
  ds_read_b128 a[36:39], v11 offset:6400
  ds_read_b128 a[16:19], v10 offset:8192
  ds_read_b128 a[40:43], v10 offset:8448
  ds_read_b128 a[20:23], v11 offset:10240
  ds_read_b128 a[44:47], v11 offset:10496
  s_waitcnt vmcnt(13)
  ds_read_b64_tr_b16 a[48:49], v9 offset:0
  ds_read_b64_tr_b16 a[50:51], v9 offset:1536
  ds_read_b64_tr_b16 a[52:53], v9 offset:32
  ds_read_b64_tr_b16 a[54:55], v9 offset:1568
  ds_read_b64_tr_b16 a[56:57], v9 offset:64
  ds_read_b64_tr_b16 a[58:59], v9 offset:1600
  s_waitcnt vmcnt(10)
  ds_read_b64_tr_b16 a[60:61], v9 offset:3072
  buffer_load_dwordx4 v4, s[8:11], s39 offen offset:1024 lds
  ds_read_b64_tr_b16 a[62:63], v9 offset:4608
  ds_read_b64_tr_b16 a[64:65], v9 offset:3104
  ds_read_b64_tr_b16 a[66:67], v9 offset:4640
  ds_read_b64_tr_b16 a[68:69], v9 offset:3136
  ds_read_b64_tr_b16 a[70:71], v9 offset:4672
  s_waitcnt vmcnt(8)
  s_waitcnt lgkmcnt(15)
  s_waitcnt lgkmcnt(6)
  v_mfma_f32_16x16x32_bf16 v[100:103], a[48:51], a[0:3], 0
  ds_read_b64_tr_b16 a[72:73], v9 offset:6144
  ds_read_b64_tr_b16 a[74:75], v9 offset:7680
  v_mfma_f32_16x16x32_bf16 v[104:107], a[48:51], a[24:27], 0
  buffer_load_dwordx4 v5, s[8:11], s39 offen offset:2048 lds
  v_mfma_f32_16x16x32_bf16 v[108:111], a[52:55], a[0:3], 0
  ds_read_b64_tr_b16 a[76:77], v9 offset:6176
  ds_read_b64_tr_b16 a[78:79], v9 offset:7712
  v_mfma_f32_16x16x32_bf16 v[112:115], a[52:55], a[24:27], 0
  s_add_u32 m0, s40, 18432
  s_mov_b32 s39, 384
  buffer_load_dwordx4 v3, s[8:11], s39 offen offset:0 lds
  v_mfma_f32_16x16x32_bf16 v[116:119], a[56:59], a[0:3], 0
  ds_read_b64_tr_b16 a[80:81], v9 offset:6208
  ds_read_b64_tr_b16 a[82:83], v9 offset:7744
  v_mfma_f32_16x16x32_bf16 v[120:123], a[56:59], a[24:27], 0
  buffer_load_dwordx4 v4, s[8:11], s39 offen offset:1024 lds
  s_waitcnt vmcnt(8)
  s_waitcnt lgkmcnt(6)
  v_mfma_f32_16x16x32_bf16 v[100:103], a[60:63], a[4:7], v[100:103]
  ds_read_b64_tr_b16 a[84:85], v9 offset:9216
  ds_read_b64_tr_b16 a[86:87], v9 offset:10752
  v_mfma_f32_16x16x32_bf16 v[104:107], a[60:63], a[28:31], v[104:107]
  buffer_load_dwordx4 v5, s[8:11], s39 offen offset:2048 lds
  v_mfma_f32_16x16x32_bf16 v[108:111], a[64:67], a[4:7], v[108:111]
  ds_read_b64_tr_b16 a[88:89], v9 offset:9248
  ds_read_b64_tr_b16 a[90:91], v9 offset:10784
  v_mfma_f32_16x16x32_bf16 v[112:115], a[64:67], a[28:31], v[112:115]
  s_add_u32 m0, s40, 21504
  s_mov_b32 s39, 37248
  buffer_load_dwordx4 v3, s[8:11], s39 offen offset:0 lds
  v_mfma_f32_16x16x32_bf16 v[116:119], a[68:71], a[4:7], v[116:119]
  ds_read_b64_tr_b16 a[92:93], v9 offset:9280
  ds_read_b64_tr_b16 a[94:95], v9 offset:10816
  v_mfma_f32_16x16x32_bf16 v[120:123], a[68:71], a[28:31], v[120:123]
  buffer_load_dwordx4 v4, s[8:11], s39 offen offset:1024 lds
  s_waitcnt vmcnt(8)
  s_waitcnt lgkmcnt(6)
  v_mfma_f32_16x16x32_bf16 v[100:103], a[72:75], a[8:11], v[100:103]
  ds_read_b64_tr_b16 a[48:49], v9 offset:12288
  ds_read_b64_tr_b16 a[50:51], v9 offset:13824
  v_mfma_f32_16x16x32_bf16 v[104:107], a[72:75], a[32:35], v[104:107]
  buffer_load_dwordx4 v5, s[8:11], s39 offen offset:2048 lds
  v_mfma_f32_16x16x32_bf16 v[108:111], a[76:79], a[8:11], v[108:111]
  ds_read_b64_tr_b16 a[52:53], v9 offset:12320
  ds_read_b64_tr_b16 a[54:55], v9 offset:13856
  v_mfma_f32_16x16x32_bf16 v[112:115], a[76:79], a[32:35], v[112:115]
  s_add_u32 m0, s40, 24576
  s_mov_b32 s39, 74112
  buffer_load_dwordx4 v3, s[8:11], s39 offen offset:0 lds
  v_mfma_f32_16x16x32_bf16 v[116:119], a[80:83], a[8:11], v[116:119]
  ds_read_b64_tr_b16 a[56:57], v9 offset:12352
  ds_read_b64_tr_b16 a[58:59], v9 offset:13888
  v_mfma_f32_16x16x32_bf16 v[120:123], a[80:83], a[32:35], v[120:123]
  buffer_load_dwordx4 v4, s[8:11], s39 offen offset:1024 lds
  s_waitcnt vmcnt(8)
  s_waitcnt lgkmcnt(6)
  v_mfma_f32_16x16x32_bf16 v[100:103], a[84:87], a[12:15], v[100:103]
  ds_read_b64_tr_b16 a[60:61], v9 offset:15360
  ds_read_b64_tr_b16 a[62:63], v9 offset:16896
  v_mfma_f32_16x16x32_bf16 v[104:107], a[84:87], a[36:39], v[104:107]
  buffer_load_dwordx4 v5, s[8:11], s39 offen offset:2048 lds
  v_mfma_f32_16x16x32_bf16 v[108:111], a[88:91], a[12:15], v[108:111]
  ds_read_b64_tr_b16 a[64:65], v9 offset:15392
  ds_read_b64_tr_b16 a[66:67], v9 offset:16928
  v_mfma_f32_16x16x32_bf16 v[112:115], a[88:91], a[36:39], v[112:115]
  s_add_u32 m0, s40, 0
  s_mov_b32 s39, 110976
  buffer_load_dwordx4 v3, s[8:11], s39 offen offset:0 lds
  v_mfma_f32_16x16x32_bf16 v[116:119], a[92:95], a[12:15], v[116:119]
  ds_read_b64_tr_b16 a[68:69], v9 offset:15424
  ds_read_b64_tr_b16 a[70:71], v9 offset:16960
  v_mfma_f32_16x16x32_bf16 v[120:123], a[92:95], a[36:39], v[120:123]
  buffer_load_dwordx4 v4, s[8:11], s39 offen offset:1024 lds
  s_waitcnt vmcnt(8)
  s_waitcnt lgkmcnt(6)
  v_mfma_f32_16x16x32_bf16 v[100:103], a[48:51], a[16:19], v[100:103]
  ds_read_b64_tr_b16 a[72:73], v9 offset:18432
  ds_read_b64_tr_b16 a[74:75], v9 offset:19968
  v_mfma_f32_16x16x32_bf16 v[104:107], a[48:51], a[40:43], v[104:107]
  buffer_load_dwordx4 v5, s[8:11], s39 offen offset:2048 lds
  v_mfma_f32_16x16x32_bf16 v[108:111], a[52:55], a[16:19], v[108:111]
  ds_read_b64_tr_b16 a[76:77], v9 offset:18464
  ds_read_b64_tr_b16 a[78:79], v9 offset:20000
  v_mfma_f32_16x16x32_bf16 v[112:115], a[52:55], a[40:43], v[112:115]
  s_add_u32 m0, s40, 3072
  s_mov_b32 s39, 147840
  buffer_load_dwordx4 v3, s[8:11], s39 offen offset:0 lds
  v_mfma_f32_16x16x32_bf16 v[116:119], a[56:59], a[16:19], v[116:119]
  ds_read_b64_tr_b16 a[80:81], v9 offset:18496
  ds_read_b64_tr_b16 a[82:83], v9 offset:20032
  v_mfma_f32_16x16x32_bf16 v[120:123], a[56:59], a[40:43], v[120:123]
  buffer_load_dwordx4 v4, s[8:11], s39 offen offset:1024 lds
  s_waitcnt vmcnt(8)
  s_waitcnt lgkmcnt(6)
  v_mfma_f32_16x16x32_bf16 v[100:103], a[60:63], a[20:23], v[100:103]
  ds_read_b64_tr_b16 a[84:85], v9 offset:21504
  ds_read_b64_tr_b16 a[86:87], v9 offset:23040
  v_mfma_f32_16x16x32_bf16 v[104:107], a[60:63], a[44:47], v[104:107]
  buffer_load_dwordx4 v5, s[8:11], s39 offen offset:2048 lds
  v_mfma_f32_16x16x32_bf16 v[108:111], a[64:67], a[20:23], v[108:111]
  ds_read_b64_tr_b16 a[88:89], v9 offset:21536
  ds_read_b64_tr_b16 a[90:91], v9 offset:23072
  v_mfma_f32_16x16x32_bf16 v[112:115], a[64:67], a[44:47], v[112:115]
  s_add_u32 m0, s40, 6144
  s_mov_b32 s39, 184704
  buffer_load_dwordx4 v3, s[8:11], s39 offen offset:0 lds
  v_mfma_f32_16x16x32_bf16 v[116:119], a[68:71], a[20:23], v[116:119]
  ds_read_b64_tr_b16 a[92:93], v9 offset:21568
  ds_read_b64_tr_b16 a[94:95], v9 offset:23104
  v_mfma_f32_16x16x32_bf16 v[120:123], a[68:71], a[44:47], v[120:123]
  buffer_load_dwordx4 v4, s[8:11], s39 offen offset:1024 lds
  s_waitcnt vmcnt(8)
  s_waitcnt lgkmcnt(6)
  v_mfma_f32_16x16x32_bf16 v[124:127], a[72:75], a[0:3], 0
  ds_read_b64_tr_b16 a[48:49], v9 offset:24576
  ds_read_b64_tr_b16 a[50:51], v9 offset:26112
  v_mfma_f32_16x16x32_bf16 v[128:131], a[72:75], a[24:27], 0
  buffer_load_dwordx4 v5, s[8:11], s39 offen offset:2048 lds
  v_mfma_f32_16x16x32_bf16 v[132:135], a[76:79], a[0:3], 0
  ds_read_b64_tr_b16 a[52:53], v9 offset:24608
  ds_read_b64_tr_b16 a[54:55], v9 offset:26144
  v_mfma_f32_16x16x32_bf16 v[136:139], a[76:79], a[24:27], 0
  s_add_u32 m0, s40, 9216
  s_mov_b32 s39, 768
  buffer_load_dwordx4 v3, s[8:11], s39 offen offset:0 lds
  v_mfma_f32_16x16x32_bf16 v[140:143], a[80:83], a[0:3], 0
  ds_read_b64_tr_b16 a[56:57], v9 offset:24640
  ds_read_b64_tr_b16 a[58:59], v9 offset:26176
  v_mfma_f32_16x16x32_bf16 v[144:147], a[80:83], a[24:27], 0
  buffer_load_dwordx4 v4, s[8:11], s39 offen offset:1024 lds
  s_waitcnt vmcnt(8)
  s_waitcnt lgkmcnt(6)
  v_mfma_f32_16x16x32_bf16 v[124:127], a[84:87], a[4:7], v[124:127]
  ds_read_b64_tr_b16 a[60:61], v9 offset:0
  ds_read_b64_tr_b16 a[62:63], v9 offset:1536
  v_mfma_f32_16x16x32_bf16 v[128:131], a[84:87], a[28:31], v[128:131]
  buffer_load_dwordx4 v5, s[8:11], s39 offen offset:2048 lds
  v_mfma_f32_16x16x32_bf16 v[132:135], a[88:91], a[4:7], v[132:135]
  ds_read_b64_tr_b16 a[64:65], v9 offset:32
  ds_read_b64_tr_b16 a[66:67], v9 offset:1568
  v_mfma_f32_16x16x32_bf16 v[136:139], a[88:91], a[28:31], v[136:139]
  s_add_u32 m0, s40, 12288
  s_mov_b32 s39, 37632
  buffer_load_dwordx4 v3, s[8:11], s39 offen offset:0 lds
  v_mfma_f32_16x16x32_bf16 v[140:143], a[92:95], a[4:7], v[140:143]
  ds_read_b64_tr_b16 a[68:69], v9 offset:64
  ds_read_b64_tr_b16 a[70:71], v9 offset:1600
  v_mfma_f32_16x16x32_bf16 v[144:147], a[92:95], a[28:31], v[144:147]
  buffer_load_dwordx4 v4, s[8:11], s39 offen offset:1024 lds
  ds_read_b64 v[228:229], v12 offset:0
  ds_read_b64 v[230:231], v12 offset:256
  ds_read_b64 v[232:233], v13 offset:0
  ds_read_b64 v[234:235], v13 offset:256
  ds_read_b64 v[236:237], v14 offset:0
  ds_read_b64 v[238:239], v14 offset:256
  s_waitcnt vmcnt(8)
  s_waitcnt lgkmcnt(12)
  v_mfma_f32_16x16x32_bf16 v[124:127], a[48:51], a[8:11], v[124:127]
  ds_read_b64_tr_b16 a[72:73], v9 offset:3072
  ds_read_b64_tr_b16 a[74:75], v9 offset:4608
  v_mfma_f32_16x16x32_bf16 v[128:131], a[48:51], a[32:35], v[128:131]
  buffer_load_dwordx4 v5, s[8:11], s39 offen offset:2048 lds
  v_mfma_f32_16x16x32_bf16 v[132:135], a[52:55], a[8:11], v[132:135]
  ds_read_b64_tr_b16 a[76:77], v9 offset:3104
  ds_read_b64_tr_b16 a[78:79], v9 offset:4640
  v_mfma_f32_16x16x32_bf16 v[136:139], a[52:55], a[32:35], v[136:139]
  s_add_u32 m0, s40, 15360
  s_mov_b32 s39, 74496
  buffer_load_dwordx4 v3, s[8:11], s39 offen offset:0 lds
  v_mfma_f32_16x16x32_bf16 v[140:143], a[56:59], a[8:11], v[140:143]
  ds_read_b64_tr_b16 a[80:81], v9 offset:3136
  ds_read_b64_tr_b16 a[82:83], v9 offset:4672
  v_mfma_f32_16x16x32_bf16 v[144:147], a[56:59], a[32:35], v[144:147]
  buffer_load_dwordx4 v4, s[8:11], s39 offen offset:1024 lds
  s_waitcnt lgkmcnt(6)
  v_lshlrev_b32 v172, 16, v228
  v_and_b32 v173, 0xffff0000, v228
  v_lshlrev_b32_e64 v174, 16, v229
  v_and_b32 v175, 0xffff0000, v229
  v_lshlrev_b32_e64 v176, 16, v230
  v_and_b32 v177, 0xffff0000, v230
  v_lshlrev_b32_e64 v178, 16, v231
  v_and_b32 v179, 0xffff0000, v231
  v_lshlrev_b32_e64 v180, 16, v232
  v_and_b32 v181, 0xffff0000, v232
  v_lshlrev_b32_e64 v182, 16, v233
  v_and_b32 v183, 0xffff0000, v233
  v_lshlrev_b32_e64 v184, 16, v234
  v_and_b32 v185, 0xffff0000, v234
  v_lshlrev_b32_e64 v186, 16, v235
  v_and_b32 v187, 0xffff0000, v235
  buffer_load_dwordx4 v5, s[8:11], s39 offen offset:2048 lds
  v_lshlrev_b32_e64 v188, 16, v236
  v_and_b32 v189, 0xffff0000, v236
  v_lshlrev_b32_e64 v190, 16, v237
  v_and_b32 v191, 0xffff0000, v237
  v_lshlrev_b32_e64 v192, 16, v238
  v_and_b32 v193, 0xffff0000, v238
  v_lshlrev_b32_e64 v194, 16, v239
  v_and_b32 v195, 0xffff0000, v239
  s_waitcnt vmcnt(9)
  v_mfma_f32_16x16x32_bf16 v[124:127], a[60:63], a[12:15], v[124:127]
  ds_read_b64_tr_b16 a[84:85], v9 offset:6144
  ds_read_b64_tr_b16 a[86:87], v9 offset:7680
  v_mfma_f32_16x16x32_bf16 v[128:131], a[60:63], a[36:39], v[128:131]
  s_add_u32 m0, s40, 18432
  s_mov_b32 s39, 111360
  buffer_load_dwordx4 v3, s[8:11], s39 offen offset:0 lds
  v_mfma_f32_16x16x32_bf16 v[132:135], a[64:67], a[12:15], v[132:135]
  ds_read_b64_tr_b16 a[88:89], v9 offset:6176
  ds_read_b64_tr_b16 a[90:91], v9 offset:7712
  v_mfma_f32_16x16x32_bf16 v[136:139], a[64:67], a[36:39], v[136:139]
  buffer_load_dwordx4 v4, s[8:11], s39 offen offset:1024 lds
  v_mfma_f32_16x16x32_bf16 v[140:143], a[68:71], a[12:15], v[140:143]
  ds_read_b64_tr_b16 a[92:93], v9 offset:6208
  ds_read_b64_tr_b16 a[94:95], v9 offset:7744
  v_mfma_f32_16x16x32_bf16 v[144:147], a[68:71], a[36:39], v[144:147]
  buffer_load_dwordx4 v5, s[8:11], s39 offen offset:2048 lds
  s_waitcnt vmcnt(9)
  s_waitcnt lgkmcnt(6)
  v_mfma_f32_16x16x32_bf16 v[124:127], a[72:75], a[16:19], v[124:127]
  ds_read_b64_tr_b16 a[48:49], v9 offset:9216
  ds_read_b64_tr_b16 a[50:51], v9 offset:10752
  v_mfma_f32_16x16x32_bf16 v[128:131], a[72:75], a[40:43], v[128:131]
  s_add_u32 m0, s40, 21504
  s_mov_b32 s39, 148224
  buffer_load_dwordx4 v3, s[8:11], s39 offen offset:0 lds
  v_mfma_f32_16x16x32_bf16 v[132:135], a[76:79], a[16:19], v[132:135]
  ds_read_b64_tr_b16 a[52:53], v9 offset:9248
  ds_read_b64_tr_b16 a[54:55], v9 offset:10784
  v_mfma_f32_16x16x32_bf16 v[136:139], a[76:79], a[40:43], v[136:139]
  buffer_load_dwordx4 v4, s[8:11], s39 offen offset:1024 lds
  v_mfma_f32_16x16x32_bf16 v[140:143], a[80:83], a[16:19], v[140:143]
  ds_read_b64_tr_b16 a[56:57], v9 offset:9280
  ds_read_b64_tr_b16 a[58:59], v9 offset:10816
  v_mfma_f32_16x16x32_bf16 v[144:147], a[80:83], a[40:43], v[144:147]
  buffer_load_dwordx4 v5, s[8:11], s39 offen offset:2048 lds
  s_waitcnt vmcnt(9)
  s_waitcnt lgkmcnt(6)
  v_mfma_f32_16x16x32_bf16 v[124:127], a[84:87], a[20:23], v[124:127]
  ds_read_b64_tr_b16 a[60:61], v9 offset:12288
  ds_read_b64_tr_b16 a[62:63], v9 offset:13824
  v_mfma_f32_16x16x32_bf16 v[128:131], a[84:87], a[44:47], v[128:131]
  s_add_u32 m0, s40, 24576
  s_mov_b32 s39, 185088
  buffer_load_dwordx4 v3, s[8:11], s39 offen offset:0 lds
  v_mfma_f32_16x16x32_bf16 v[132:135], a[88:91], a[20:23], v[132:135]
  ds_read_b64_tr_b16 a[64:65], v9 offset:12320
  ds_read_b64_tr_b16 a[66:67], v9 offset:13856
  v_mfma_f32_16x16x32_bf16 v[136:139], a[88:91], a[44:47], v[136:139]
  buffer_load_dwordx4 v4, s[8:11], s39 offen offset:1024 lds
  v_mfma_f32_16x16x32_bf16 v[140:143], a[92:95], a[20:23], v[140:143]
  ds_read_b64_tr_b16 a[68:69], v9 offset:12352
  ds_read_b64_tr_b16 a[70:71], v9 offset:13888
  v_mfma_f32_16x16x32_bf16 v[144:147], a[92:95], a[44:47], v[144:147]
  buffer_load_dwordx4 v5, s[8:11], s39 offen offset:2048 lds
  s_nop 2
  v_cvt_pk_bf16_f32 v196, v100, v101
  v_cvt_pk_bf16_f32 v197, v102, v103
  v_cvt_pk_bf16_f32 v202, v104, v105
  v_cvt_pk_bf16_f32 v203, v106, v107
  v_cvt_pk_bf16_f32 v198, v108, v109
  v_cvt_pk_bf16_f32 v199, v110, v111
  v_cvt_pk_bf16_f32 v204, v112, v113
  v_cvt_pk_bf16_f32 v205, v114, v115
  v_cvt_pk_bf16_f32 v200, v116, v117
  v_cvt_pk_bf16_f32 v201, v118, v119
  v_cvt_pk_bf16_f32 v206, v120, v121
  v_cvt_pk_bf16_f32 v207, v122, v123
  v_cvt_pk_bf16_f32 v208, v124, v125
  v_cvt_pk_bf16_f32 v209, v126, v127
  s_add_u32 m0, s40, 0
  s_mov_b32 s39, 0
  buffer_load_dwordx4 v6, s[12:15], s39 offen offset:0 lds
  v_cvt_pk_bf16_f32 v214, v128, v129
  v_cvt_pk_bf16_f32 v215, v130, v131
  v_cvt_pk_bf16_f32 v210, v132, v133
  v_cvt_pk_bf16_f32 v211, v134, v135
  v_cvt_pk_bf16_f32 v216, v136, v137
  v_cvt_pk_bf16_f32 v217, v138, v139
  v_cvt_pk_bf16_f32 v212, v140, v141
  v_cvt_pk_bf16_f32 v213, v142, v143
  v_cvt_pk_bf16_f32 v218, v144, v145
  v_cvt_pk_bf16_f32 v219, v146, v147
  s_lshl_b32 s31, s28, 11
  s_add_u32 s31, s31, 147456
  v_mfma_f32_16x16x32_bf16 v[220:223], v[208:211], v[196:199], 0
  v_mfma_f32_16x16x32_bf16 v[224:227], v[214:217], v[202:205], 0
  buffer_load_dwordx4 v7, s[12:15], s39 offen offset:1024 lds
  v_add_u32 v57, s31, v17
  v_add_u32 v62, 147456, v17
  v_mfma_f32_16x16x16_bf16 v[220:223], v[212:213], v[200:201], v[220:223]
  v_mfma_f32_16x16x16_bf16 v[224:227], v[218:219], v[206:207], v[224:227]
  s_nop 6
  ds_write_b128 v57, v[220:223] offset:0
  buffer_load_dwordx4 v8, s[12:15], s39 offen offset:2048 lds
  ds_write_b128 v57, v[224:227] offset:1024
  s_waitcnt vmcnt(12)
  s_waitcnt lgkmcnt(8)
  v_mfma_f32_16x16x32_bf16 v[148:151], a[0:3], a[48:51], 0
  ds_read_b64_tr_b16 a[72:73], v9 offset:15360
  ds_read_b64_tr_b16 a[74:75], v9 offset:16896
  v_mfma_f32_16x16x32_bf16 v[152:155], a[24:27], a[48:51], 0
  s_add_u32 m0, s40, 3072
  s_mov_b32 s39, 12288
  buffer_load_dwordx4 v6, s[12:15], s39 offen offset:0 lds
  v_mfma_f32_16x16x32_bf16 v[156:159], a[0:3], a[52:55], 0
  ds_read_b64_tr_b16 a[76:77], v9 offset:15392
  ds_read_b64_tr_b16 a[78:79], v9 offset:16928
  v_mfma_f32_16x16x32_bf16 v[160:163], a[24:27], a[52:55], 0
  buffer_load_dwordx4 v7, s[12:15], s39 offen offset:1024 lds
  v_mfma_f32_16x16x32_bf16 v[164:167], a[0:3], a[56:59], 0
  ds_read_b64_tr_b16 a[80:81], v9 offset:15424
  ds_read_b64_tr_b16 a[82:83], v9 offset:16960
  v_mfma_f32_16x16x32_bf16 v[168:171], a[24:27], a[56:59], 0
  buffer_load_dwordx4 v8, s[12:15], s39 offen offset:2048 lds
  s_waitcnt lgkmcnt(6)
  s_barrier
  ds_read_b128 v[196:199], v62 offset:0
  ds_read_b128 v[200:203], v62 offset:1024
  ds_read_b128 v[204:207], v62 offset:2048
  ds_read_b128 v[208:211], v62 offset:3072
  ds_read_b128 v[212:215], v62 offset:4096
  ds_read_b128 v[216:219], v62 offset:5120
  ds_read_b128 v[220:223], v62 offset:6144
  ds_read_b128 v[224:227], v62 offset:7168
  v_and_b32 v233, 15, v1
  v_lshrrev_b32 v234, 4, v1
  v_lshrrev_b32 v228, 1, v234
  v_and_b32_e64 v230, 1, v234
  v_lshl_add_u32 v231, v230, 4, v233
  v_and_b32 v232, 7, v231
  v_lshrrev_b32 v231, 3, v231
  s_add_u32 m0, s40, 6144
  s_mov_b32 s39, 24576
  buffer_load_dwordx4 v6, s[12:15], s39 offen offset:0 lds
  v_mul_u32_u24 v229, 282624, v232
  s_bfe_u32 s31, s30, 0x10001
  v_lshl_add_u32 v229, v231, 4, v229
  v_xor_b32_e64 v16, s31, v228
  v_lshl_add_u32 v16, v16, 6, v229
  v_mul_u32_u24 v232, 736, v232
  s_lshl_b32 s31, s29, 5
  s_lshl_b32 s34, s30, 2
  v_add_u32 v232, v232, v231
  s_add_u32 s31, s31, s34
  v_add_u32_e64 v232, s31, v232
  v_cmp_lt_u32 s[44:45], 31, v1
  v_lshlrev_b32 v232, 3, v232
  v_mov_b32 v229, 0x40000000
  v_add_u32 v232, 2359296, v232
  s_lshl_b32 s31, s28, 8
  v_cndmask_b32 v24, v232, v229, s[44:45]
  buffer_load_dwordx4 v7, s[12:15], s39 offen offset:1024 lds
  v_lshlrev_b32 v232, 3, v233
  s_add_u32 s31, s31, 155648
  v_add_u32 v26, 155648, v232
  v_add_u32 v25, s31, v232
  s_waitcnt vmcnt(14)
  v_mfma_f32_16x16x32_bf16 v[148:151], a[4:7], a[60:63], v[148:151]
  ds_read_b64_tr_b16 a[84:85], v9 offset:18432
  ds_read_b64_tr_b16 a[86:87], v9 offset:19968
  v_mfma_f32_16x16x32_bf16 v[152:155], a[28:31], a[60:63], v[152:155]
  buffer_load_dwordx4 v8, s[12:15], s39 offen offset:2048 lds
  v_mfma_f32_16x16x32_bf16 v[156:159], a[4:7], a[64:67], v[156:159]
  ds_read_b64_tr_b16 a[88:89], v9 offset:18464
  ds_read_b64_tr_b16 a[90:91], v9 offset:20000
  v_mfma_f32_16x16x32_bf16 v[160:163], a[28:31], a[64:67], v[160:163]
  s_add_u32 m0, s40, 9216
  s_mov_b32 s39, 36864
  buffer_load_dwordx4 v6, s[12:15], s39 offen offset:0 lds
  v_mfma_f32_16x16x32_bf16 v[164:167], a[4:7], a[68:71], v[164:167]
  ds_read_b64_tr_b16 a[92:93], v9 offset:18496
  ds_read_b64_tr_b16 a[94:95], v9 offset:20032
  v_mfma_f32_16x16x32_bf16 v[168:171], a[28:31], a[68:71], v[168:171]
  buffer_load_dwordx4 v7, s[12:15], s39 offen offset:1024 lds
  s_waitcnt lgkmcnt(6)
  s_mov_b32 s63, 0x3dd53b95
  v_pk_add_f32 v[196:197], v[196:197], v[204:205]
  v_pk_add_f32 v[212:213], v[212:213], v[220:221]
  v_pk_add_f32 v[198:199], v[198:199], v[206:207]
  v_pk_add_f32 v[214:215], v[214:215], v[222:223]
  v_pk_add_f32 v[200:201], v[200:201], v[208:209]
  v_pk_add_f32 v[216:217], v[216:217], v[224:225]
  v_pk_add_f32 v[202:203], v[202:203], v[210:211]
  v_pk_add_f32 v[218:219], v[218:219], v[226:227]
  v_pk_add_f32 v[196:197], v[196:197], v[212:213]
  v_pk_add_f32 v[198:199], v[198:199], v[214:215]
  v_pk_add_f32 v[200:201], v[200:201], v[216:217]
  v_pk_add_f32 v[202:203], v[202:203], v[218:219]
  v_max3_f32 v204, v196, v197, v198
  v_max3_f32 v205, v200, v201, v202
  v_max_f32 v204, v204, v199
  buffer_load_dwordx4 v8, s[12:15], s39 offen offset:2048 lds
  v_max_f32 v205, v205, v203
  v_mov_b32 v206, v204
  v_mov_b32 v207, v205
  s_nop 0
  v_permlane16_swap_b32 v204, v206
  v_permlane16_swap_b32 v205, v207
  v_max_f32 v204, v204, v206
  v_max_f32 v205, v205, v207
  v_mul_f32 v204, s63, v204
  v_mul_f32 v205, s63, v205
  v_fma_f32 v196, v196, s63, -v204
  v_fma_f32 v197, v197, s63, -v204
  v_fma_f32 v198, v198, s63, -v204
  v_fma_f32 v199, v199, s63, -v204
  v_fma_f32 v200, v200, s63, -v205
  v_fma_f32 v201, v201, s63, -v205
  v_fma_f32 v202, v202, s63, -v205
  s_add_u32 m0, s40, 12288
  s_mov_b32 s39, 49152
  buffer_load_dwordx4 v6, s[12:15], s39 offen offset:0 lds
  v_fma_f32 v203, v203, s63, -v205
  v_exp_f32 v196, v196
  v_exp_f32 v197, v197
  v_exp_f32 v198, v198
  v_exp_f32 v199, v199
  v_exp_f32 v200, v200
  v_exp_f32 v201, v201
  v_exp_f32 v202, v202
  v_exp_f32 v203, v203
  buffer_load_dwordx4 v7, s[12:15], s39 offen offset:1024 lds
  s_nop 0
  v_add_f32 v204, v196, v197
  v_add_f32 v206, v198, v199
  v_add_f32 v205, v200, v201
  v_add_f32 v207, v202, v203
  v_add_f32 v204, v204, v206
  v_add_f32 v205, v205, v207
  v_mov_b32 v206, v204
  v_mov_b32 v207, v205
  s_nop 0
  v_permlane16_swap_b32 v204, v206
  v_permlane16_swap_b32 v205, v207
  v_add_f32 v204, v204, v206
  v_add_f32 v205, v205, v207
  v_rcp_f32 v204, v204
  v_rcp_f32 v205, v205
  buffer_load_dwordx4 v8, s[12:15], s39 offen offset:2048 lds
  s_nop 0
  v_mul_f32 v196, v196, v204
  v_mul_f32 v197, v197, v204
  v_mul_f32 v198, v198, v204
  v_mul_f32 v199, v199, v204
  v_mul_f32 v200, v200, v205
  v_mul_f32 v201, v201, v205
  v_mul_f32 v202, v202, v205
  v_mul_f32_e64 v203, v203, v205
  v_cvt_pk_bf16_f32 v240, v196, v197
  v_cvt_pk_bf16_f32 v241, v198, v199
  v_cvt_pk_bf16_f32 v242, v200, v201
  v_cvt_pk_bf16_f32 v243, v202, v203
  v_cndmask_b32 v240, 0, v240, s[42:43]
  v_cndmask_b32 v241, 0, v241, s[42:43]
  v_cndmask_b32 v242, 0, v242, s[42:43]
  v_cndmask_b32 v243, 0, v243, s[42:43]
  s_waitcnt vmcnt(18)
  v_mfma_f32_16x16x32_bf16 v[148:151], a[8:11], a[72:75], v[148:151]
  ds_read_b64_tr_b16 a[48:49], v9 offset:21504
  ds_read_b64_tr_b16 a[50:51], v9 offset:23040
  v_mfma_f32_16x16x32_bf16 v[152:155], a[32:35], a[72:75], v[152:155]
  s_add_u32 m0, s40, 15360
  s_mov_b32 s39, 61440
  buffer_load_dwordx4 v6, s[12:15], s39 offen offset:0 lds
  v_mfma_f32_16x16x32_bf16 v[156:159], a[8:11], a[76:79], v[156:159]
  ds_read_b64_tr_b16 a[52:53], v9 offset:21536
  ds_read_b64_tr_b16 a[54:55], v9 offset:23072
  v_mfma_f32_16x16x32_bf16 v[160:163], a[32:35], a[76:79], v[160:163]
  buffer_load_dwordx4 v7, s[12:15], s39 offen offset:1024 lds
  v_mfma_f32_16x16x32_bf16 v[164:167], a[8:11], a[80:83], v[164:167]
  ds_read_b64_tr_b16 a[56:57], v9 offset:21568
  ds_read_b64_tr_b16 a[58:59], v9 offset:23104
  v_mfma_f32_16x16x32_bf16 v[168:171], a[32:35], a[80:83], v[168:171]
  buffer_load_dwordx4 v8, s[12:15], s39 offen offset:2048 lds
  v_mov_b32 v62, 0
  buffer_load_dword v63, v62, s[24:27], 0 offen sc1
  s_waitcnt vmcnt(19)
  s_waitcnt lgkmcnt(6)
  v_mfma_f32_16x16x32_bf16 v[148:151], a[12:15], a[84:87], v[148:151]
  ds_read_b64_tr_b16 a[60:61], v9 offset:24576
  ds_read_b64_tr_b16 a[62:63], v9 offset:26112
  v_mfma_f32_16x16x32_bf16 v[152:155], a[36:39], a[84:87], v[152:155]
  v_mfma_f32_16x16x32_bf16 v[156:159], a[12:15], a[88:91], v[156:159]
  ds_read_b64_tr_b16 a[64:65], v9 offset:24608
  ds_read_b64_tr_b16 a[66:67], v9 offset:26144
  v_mfma_f32_16x16x32_bf16 v[160:163], a[36:39], a[88:91], v[160:163]
  v_mfma_f32_16x16x32_bf16 v[164:167], a[12:15], a[92:95], v[164:167]
  ds_read_b64_tr_b16 a[68:69], v9 offset:24640
  ds_read_b64_tr_b16 a[70:71], v9 offset:26176
  v_mfma_f32_16x16x32_bf16 v[168:171], a[36:39], a[92:95], v[168:171]
  s_waitcnt vmcnt(16)
  s_waitcnt lgkmcnt(6)
  v_mfma_f32_16x16x32_bf16 v[148:151], a[16:19], a[48:51], v[148:151]
  ds_read_b64_tr_b16 a[72:73], v9 offset:0
  ds_read_b64_tr_b16 a[74:75], v9 offset:1536
  v_mfma_f32_16x16x32_bf16 v[152:155], a[40:43], a[48:51], v[152:155]
  v_mfma_f32_16x16x32_bf16 v[156:159], a[16:19], a[52:55], v[156:159]
  ds_read_b64_tr_b16 a[76:77], v9 offset:32
  ds_read_b64_tr_b16 a[78:79], v9 offset:1568
  v_mfma_f32_16x16x32_bf16 v[160:163], a[40:43], a[52:55], v[160:163]
  v_mfma_f32_16x16x32_bf16 v[164:167], a[16:19], a[56:59], v[164:167]
  ds_read_b64_tr_b16 a[80:81], v9 offset:64
  ds_read_b64_tr_b16 a[82:83], v9 offset:1600
  v_mfma_f32_16x16x32_bf16 v[168:171], a[40:43], a[56:59], v[168:171]
  s_waitcnt vmcnt(13)
  s_waitcnt lgkmcnt(6)
  v_mfma_f32_16x16x32_bf16 v[148:151], a[20:23], a[60:63], v[148:151]
  ds_read_b64_tr_b16 a[84:85], v9 offset:3072
  ds_read_b64_tr_b16 a[86:87], v9 offset:4608
  v_mfma_f32_16x16x32_bf16 v[152:155], a[44:47], a[60:63], v[152:155]
  v_mfma_f32_16x16x32_bf16 v[156:159], a[20:23], a[64:67], v[156:159]
  ds_read_b64_tr_b16 a[88:89], v9 offset:3104
  ds_read_b64_tr_b16 a[90:91], v9 offset:4640
  v_mfma_f32_16x16x32_bf16 v[160:163], a[44:47], a[64:67], v[160:163]
  v_mfma_f32_16x16x32_bf16 v[164:167], a[20:23], a[68:71], v[164:167]
  ds_read_b64_tr_b16 a[92:93], v9 offset:3136
  ds_read_b64_tr_b16 a[94:95], v9 offset:4672
  v_mfma_f32_16x16x32_bf16 v[168:171], a[44:47], a[68:71], v[168:171]
  s_nop 2
  v_cvt_pk_bf16_f32 v196, v148, v149
  v_cvt_pk_bf16_f32 v197, v150, v151
  v_cvt_pk_bf16_f32 v198, v152, v153
  v_cvt_pk_bf16_f32 v199, v154, v155
  v_cvt_pk_bf16_f32 v200, v156, v157
  v_cvt_pk_bf16_f32 v201, v158, v159
  v_cvt_pk_bf16_f32 v202, v160, v161
  v_cvt_pk_bf16_f32 v203, v162, v163
  v_cvt_pk_bf16_f32 v204, v164, v165
  v_cvt_pk_bf16_f32 v205, v166, v167
  v_cvt_pk_bf16_f32 v206, v168, v169
  v_cvt_pk_bf16_f32 v207, v170, v171
  s_nop 0
  v_mfma_f32_16x16x16_bf16 v[148:151], v[196:197], v[240:241], 0
  v_mfma_f32_16x16x16_bf16 v[152:155], v[198:199], v[242:243], 0
  v_mfma_f32_16x16x16_bf16 v[156:159], v[200:201], v[240:241], 0
  v_mfma_f32_16x16x16_bf16 v[160:163], v[202:203], v[242:243], 0
  v_mfma_f32_16x16x16_bf16 v[164:167], v[204:205], v[240:241], 0
  v_mfma_f32_16x16x16_bf16 v[168:171], v[206:207], v[242:243], 0
  s_nop 2
  v_cvt_pk_bf16_f32 v208, v148, v149
  v_cvt_pk_bf16_f32 v209, v150, v151
  ds_write_b64 v12, v[208:209] offset:12288
  v_cvt_pk_bf16_f32 v210, v152, v153
  v_cvt_pk_bf16_f32 v211, v154, v155
  ds_write_b64 v12, v[210:211] offset:12544
  v_cvt_pk_bf16_f32 v212, v156, v157
  v_cvt_pk_bf16_f32 v213, v158, v159
  ds_write_b64 v13, v[212:213] offset:12288
  v_cvt_pk_bf16_f32 v214, v160, v161
  v_cvt_pk_bf16_f32 v215, v162, v163
  ds_write_b64 v13, v[214:215] offset:12544
  v_cvt_pk_bf16_f32 v216, v164, v165
  v_cvt_pk_bf16_f32 v217, v166, v167
  ds_write_b64 v14, v[216:217] offset:12288
  v_cvt_pk_bf16_f32 v218, v168, v169
  v_cvt_pk_bf16_f32 v219, v170, v171
  ds_write_b64 v14, v[218:219] offset:12544
  s_waitcnt lgkmcnt(0)
  s_barrier
  ds_read_b128 a[96:99], v10 offset:24576
  ds_read_b128 a[120:123], v10 offset:24832
  ds_read_b128 a[100:103], v11 offset:26624
  ds_read_b128 a[124:127], v11 offset:26880
  ds_read_b128 a[104:107], v10 offset:28672
  ds_read_b128 a[128:131], v10 offset:28928
  ds_read_b128 a[108:111], v11 offset:30720
  ds_read_b128 a[132:135], v11 offset:30976
  ds_read_b128 a[112:115], v10 offset:32768
  ds_read_b128 a[136:139], v10 offset:33024
  ds_read_b128 a[116:119], v11 offset:34816
  ds_read_b128 a[140:143], v11 offset:35072
  s_waitcnt vmcnt(10)
  s_waitcnt lgkmcnt(10)
  v_mfma_f32_16x16x32_bf16 v[172:175], a[72:75], a[96:99], v[172:175]
  ds_read_b64_tr_b16 a[48:49], v9 offset:6144
  ds_read_b64_tr_b16 a[50:51], v9 offset:7680
  v_mfma_f32_16x16x32_bf16 v[176:179], a[72:75], a[120:123], v[176:179]
  v_mfma_f32_16x16x32_bf16 v[180:183], a[76:79], a[96:99], v[180:183]
  ds_read_b64_tr_b16 a[52:53], v9 offset:6176
  ds_read_b64_tr_b16 a[54:55], v9 offset:7712
  v_mfma_f32_16x16x32_bf16 v[184:187], a[76:79], a[120:123], v[184:187]
  v_mfma_f32_16x16x32_bf16 v[188:191], a[80:83], a[96:99], v[188:191]
  ds_read_b64_tr_b16 a[56:57], v9 offset:6208
  ds_read_b64_tr_b16 a[58:59], v9 offset:7744
  v_mfma_f32_16x16x32_bf16 v[192:195], a[80:83], a[120:123], v[192:195]
  s_waitcnt vmcnt(7)
  s_waitcnt lgkmcnt(14)
  v_mfma_f32_16x16x32_bf16 v[172:175], a[84:87], a[100:103], v[172:175]
  ds_read_b64_tr_b16 a[60:61], v9 offset:9216
  ds_read_b64_tr_b16 a[62:63], v9 offset:10752
  v_mfma_f32_16x16x32_bf16 v[176:179], a[84:87], a[124:127], v[176:179]
  v_mfma_f32_16x16x32_bf16 v[180:183], a[88:91], a[100:103], v[180:183]
  ds_read_b64_tr_b16 a[64:65], v9 offset:9248
  ds_read_b64_tr_b16 a[66:67], v9 offset:10784
  v_mfma_f32_16x16x32_bf16 v[184:187], a[88:91], a[124:127], v[184:187]
  v_mfma_f32_16x16x32_bf16 v[188:191], a[92:95], a[100:103], v[188:191]
  ds_read_b64_tr_b16 a[68:69], v9 offset:9280
  ds_read_b64_tr_b16 a[70:71], v9 offset:10816
  v_mfma_f32_16x16x32_bf16 v[192:195], a[92:95], a[124:127], v[192:195]
  s_waitcnt vmcnt(4)
  s_waitcnt lgkmcnt(15)
  s_waitcnt lgkmcnt(6)
  v_mfma_f32_16x16x32_bf16 v[172:175], a[48:51], a[104:107], v[172:175]
  ds_read_b64_tr_b16 a[72:73], v9 offset:12288
  ds_read_b64_tr_b16 a[74:75], v9 offset:13824
  v_mfma_f32_16x16x32_bf16 v[176:179], a[48:51], a[128:131], v[176:179]
  v_mfma_f32_16x16x32_bf16 v[180:183], a[52:55], a[104:107], v[180:183]
  ds_read_b64_tr_b16 a[76:77], v9 offset:12320
  ds_read_b64_tr_b16 a[78:79], v9 offset:13856
  v_mfma_f32_16x16x32_bf16 v[184:187], a[52:55], a[128:131], v[184:187]
  v_mfma_f32_16x16x32_bf16 v[188:191], a[56:59], a[104:107], v[188:191]
  ds_read_b64_tr_b16 a[80:81], v9 offset:12352
  ds_read_b64_tr_b16 a[82:83], v9 offset:13888
  v_mfma_f32_16x16x32_bf16 v[192:195], a[56:59], a[128:131], v[192:195]
  s_waitcnt vmcnt(1)
  s_waitcnt lgkmcnt(6)
  v_mfma_f32_16x16x32_bf16 v[172:175], a[60:63], a[108:111], v[172:175]
  ds_read_b64_tr_b16 a[84:85], v9 offset:15360
  ds_read_b64_tr_b16 a[86:87], v9 offset:16896
  v_mfma_f32_16x16x32_bf16 v[176:179], a[60:63], a[132:135], v[176:179]
  v_mfma_f32_16x16x32_bf16 v[180:183], a[64:67], a[108:111], v[180:183]
  ds_read_b64_tr_b16 a[88:89], v9 offset:15392
  ds_read_b64_tr_b16 a[90:91], v9 offset:16928
  v_mfma_f32_16x16x32_bf16 v[184:187], a[64:67], a[132:135], v[184:187]
  v_mfma_f32_16x16x32_bf16 v[188:191], a[68:71], a[108:111], v[188:191]
  ds_read_b64_tr_b16 a[92:93], v9 offset:15424
  ds_read_b64_tr_b16 a[94:95], v9 offset:16960
  v_mfma_f32_16x16x32_bf16 v[192:195], a[68:71], a[132:135], v[192:195]
  s_waitcnt lgkmcnt(6)
  v_mfma_f32_16x16x32_bf16 v[172:175], a[72:75], a[112:115], v[172:175]
  v_mfma_f32_16x16x32_bf16 v[176:179], a[72:75], a[136:139], v[176:179]
  v_mfma_f32_16x16x32_bf16 v[180:183], a[76:79], a[112:115], v[180:183]
  v_mfma_f32_16x16x32_bf16 v[184:187], a[76:79], a[136:139], v[184:187]
  v_mfma_f32_16x16x32_bf16 v[188:191], a[80:83], a[112:115], v[188:191]
  v_mfma_f32_16x16x32_bf16 v[192:195], a[80:83], a[136:139], v[192:195]
  s_waitcnt vmcnt(0)
  s_mov_b32 s31, 1048576
L_fpoll:
  v_cmp_le_u32 vcc, 72, v63
  s_cbranch_vccnz L_fdone
  buffer_load_dword v63, v62, s[24:27], 0 offen sc1
  s_sub_u32 s31, s31, 1
  s_waitcnt vmcnt(0)
  s_cmp_lg_u32 s31, 0
  s_cbranch_scc1 L_fpoll
L_fdone:
  s_mul_i32 s31, s29, 52
  s_mul_i32 s34, s28, 13
  s_add_u32 s31, s31, s34
  v_min_u32 v62, 12, v1
  v_add_u32 v62, s31, v62
  v_add_u32 v63, 448, v62
  v_cmp_gt_u32 vcc, 576, v62
  s_mov_b32 s31, 4718592
  s_nop 0
  v_cndmask_b32 v62, v63, v62, vcc
  v_lshlrev_b32_e64 v62, 7, v62
  buffer_load_dword v63, v62, s[16:19], s31 offen sc1
  s_waitcnt lgkmcnt(0)
  v_mfma_f32_16x16x32_bf16 v[172:175], a[84:87], a[116:119], v[172:175]
  v_mfma_f32_16x16x32_bf16 v[176:179], a[84:87], a[140:143], v[176:179]
  v_mfma_f32_16x16x32_bf16 v[180:183], a[88:91], a[116:119], v[180:183]
  v_mfma_f32_16x16x32_bf16 v[184:187], a[88:91], a[140:143], v[184:187]
  v_mfma_f32_16x16x32_bf16 v[188:191], a[92:95], a[116:119], v[188:191]
  v_mfma_f32_16x16x32_bf16 v[192:195], a[92:95], a[140:143], v[192:195]
  s_nop 2
  v_pk_add_f32 v[196:197], v[172:173], v[174:175]
  v_pk_mul_f32 v[200:201], v[172:173], v[172:173]
  v_pk_add_f32 v[198:199], v[176:177], v[178:179]
  v_pk_mul_f32 v[202:203], v[176:177], v[176:177]
  v_pk_fma_f32 v[200:201], v[174:175], v[174:175], v[200:201]
  v_pk_fma_f32 v[202:203], v[178:179], v[178:179], v[202:203]
  v_pk_add_f32 v[196:197], v[196:197], v[180:181]
  v_pk_fma_f32 v[200:201], v[180:181], v[180:181], v[200:201]
  v_pk_add_f32 v[196:197], v[196:197], v[182:183]
  v_pk_fma_f32 v[200:201], v[182:183], v[182:183], v[200:201]
  v_pk_add_f32 v[198:199], v[198:199], v[184:185]
  v_pk_fma_f32 v[202:203], v[184:185], v[184:185], v[202:203]
  v_pk_add_f32 v[198:199], v[198:199], v[186:187]
  v_pk_fma_f32 v[202:203], v[186:187], v[186:187], v[202:203]
  v_pk_add_f32 v[196:197], v[196:197], v[188:189]
  v_pk_fma_f32 v[200:201], v[188:189], v[188:189], v[200:201]
  v_pk_add_f32 v[196:197], v[196:197], v[190:191]
  v_pk_fma_f32 v[200:201], v[190:191], v[190:191], v[200:201]
  v_pk_add_f32 v[198:199], v[198:199], v[192:193]
  v_pk_fma_f32 v[202:203], v[192:193], v[192:193], v[202:203]
  v_pk_add_f32 v[198:199], v[198:199], v[194:195]
  v_pk_fma_f32 v[202:203], v[194:195], v[194:195], v[202:203]
  v_add_f32 v204, v196, v197
  v_add_f32 v205, v200, v201
  v_add_f32 v206, v198, v199
  v_add_f32 v207, v202, v203
  v_mov_b32 v196, v204
  v_mov_b32 v197, v205
  v_mov_b32 v198, v206
  v_mov_b32 v199, v207
  v_permlane16_swap_b32 v204, v196
  v_permlane16_swap_b32 v205, v197
  v_permlane16_swap_b32 v206, v198
  v_permlane16_swap_b32 v207, v199
  v_add_f32 v204, v204, v196
  v_add_f32 v205, v205, v197
  v_add_f32 v206, v206, v198
  v_add_f32 v207, v207, v199
  v_mov_b32 v196, v204
  v_mov_b32 v197, v205
  v_mov_b32 v198, v206
  v_mov_b32 v199, v207
  v_permlane32_swap_b32 v204, v196
  v_permlane32_swap_b32 v205, v197
  v_permlane32_swap_b32 v206, v198
  v_permlane32_swap_b32 v207, v199
  v_add_f32 v204, v204, v196
  v_add_f32 v205, v205, v197
  v_add_f32 v206, v206, v198
  v_add_f32 v207, v207, v199
  ds_write_b64 v25, v[204:205] offset:0
  ds_write_b64 v25, v[206:207] offset:128
  s_mov_b32 s61, 0x3baaaaab
  s_mov_b32 s62, 0x3727c5ac
  s_waitcnt lgkmcnt(0)
  s_barrier
  ds_read_b64 v[64:65], v26 offset:0
  ds_read_b64 v[66:67], v26 offset:256
  ds_read_b64 v[68:69], v26 offset:512
  ds_read_b64 v[70:71], v26 offset:768
  ds_read_b64 v[72:73], v26 offset:128
  ds_read_b64 v[74:75], v26 offset:384
  ds_read_b64 v[76:77], v26 offset:640
  ds_read_b64 v[78:79], v26 offset:896
  s_waitcnt lgkmcnt(4)
  v_pk_add_f32 v[64:65], v[64:65], v[66:67]
  v_pk_add_f32 v[68:69], v[68:69], v[70:71]
  s_waitcnt lgkmcnt(0)
  v_pk_add_f32 v[72:73], v[72:73], v[74:75]
  v_pk_add_f32 v[76:77], v[76:77], v[78:79]
  v_pk_add_f32 v[64:65], v[64:65], v[68:69]
  v_pk_add_f32 v[72:73], v[72:73], v[76:77]
  v_mul_f32 v64, s61, v64
  v_mov_b32 v66, s62
  v_mul_f32 v72, s61, v72
  v_mov_b32 v74, s62
  v_fmac_f32 v66, s61, v65
  v_fmac_f32 v74, s61, v73
  v_fma_f32 v66, -v64, v64, v66
  v_fma_f32 v74, -v72, v72, v74
  v_max_f32 v70, s62, v66
  v_max_f32 v78, s62, v74
  v_rsq_f32 v66, v70
  v_rsq_f32 v74, v78
  s_nop 0
  v_mul_f32 v68, v64, v66
  v_mov_b32 v67, v66
  v_mov_b32 v69, v68
  v_mul_f32 v76, v72, v74
  v_mov_b32 v75, v74
  v_mov_b32_e64 v77, v76
  v_pk_fma_f32 v[172:173], v[172:173], v[66:67], v[68:69] neg_lo:[0,0,1] neg_hi:[0,0,1]
  v_pk_fma_f32 v[174:175], v[174:175], v[66:67], v[68:69] neg_lo:[0,0,1] neg_hi:[0,0,1]
  v_pk_fma_f32 v[176:177], v[176:177], v[74:75], v[76:77] neg_lo:[0,0,1] neg_hi:[0,0,1]
  v_pk_fma_f32 v[178:179], v[178:179], v[74:75], v[76:77] neg_lo:[0,0,1] neg_hi:[0,0,1]
  v_cvt_pk_bf16_f32 v224, v172, v173
  v_cvt_pk_bf16_f32 v225, v174, v175
  v_cvt_pk_bf16_f32 v226, v176, v177
  v_cvt_pk_bf16_f32 v227, v178, v179
  v_pk_fma_f32 v[180:181], v[180:181], v[66:67], v[68:69] neg_lo:[0,0,1] neg_hi:[0,0,1]
  v_pk_fma_f32 v[182:183], v[182:183], v[66:67], v[68:69] neg_lo:[0,0,1] neg_hi:[0,0,1]
  v_pk_fma_f32 v[184:185], v[184:185], v[74:75], v[76:77] neg_lo:[0,0,1] neg_hi:[0,0,1]
  v_pk_fma_f32 v[186:187], v[186:187], v[74:75], v[76:77] neg_lo:[0,0,1] neg_hi:[0,0,1]
  v_cvt_pk_bf16_f32 v228, v180, v181
  v_cvt_pk_bf16_f32 v229, v182, v183
  v_cvt_pk_bf16_f32 v230, v184, v185
  v_cvt_pk_bf16_f32 v231, v186, v187
  v_permlane16_swap_b32 v224, v226
  v_permlane16_swap_b32 v225, v227
  buffer_store_dwordx4 v[224:227], v16, s[16:19], s55 offen sc1
  v_pk_fma_f32 v[188:189], v[188:189], v[66:67], v[68:69] neg_lo:[0,0,1] neg_hi:[0,0,1]
  v_pk_fma_f32 v[190:191], v[190:191], v[66:67], v[68:69] neg_lo:[0,0,1] neg_hi:[0,0,1]
  v_pk_fma_f32 v[192:193], v[192:193], v[74:75], v[76:77] neg_lo:[0,0,1] neg_hi:[0,0,1]
  v_pk_fma_f32 v[194:195], v[194:195], v[74:75], v[76:77] neg_lo:[0,0,1] neg_hi:[0,0,1]
  v_cvt_pk_bf16_f32 v232, v188, v189
  v_cvt_pk_bf16_f32 v233, v190, v191
  v_cvt_pk_bf16_f32 v234, v192, v193
  v_cvt_pk_bf16_f32 v235, v194, v195
  v_permlane16_swap_b32 v228, v230
  v_permlane16_swap_b32 v229, v231
  buffer_store_dwordx4 v[228:231], v16, s[16:19], s56 offen sc1
  v_mul_f32 v65, v70, v66
  v_mul_f32 v73, v78, v74
  v_permlane16_swap_b32 v232, v234
  v_permlane16_swap_b32 v233, v235
  buffer_store_dwordx4 v[232:235], v16, s[16:19], s57 offen sc1
  v_and_b32 v62, 16, v1
  v_cmp_eq_u32 vcc, 0, v62
  s_cmp_lg_u32 s28, 0
  s_cbranch_scc1 L_nostat
  v_cndmask_b32 v196, v72, v64, vcc
  v_cndmask_b32 v197, v73, v65, vcc
  buffer_store_dwordx2 v[196:197], v24, s[16:19], 0 offen sc1
L_nostat:
  v_and_b32 v105, 15, v1
  v_lshrrev_b32 v106, 4, v1
  s_mul_i32 s60, s28, 36864
  s_mul_i32 s59, s30, 282624
  v_add_u32 v28, 36864, v10
  v_add_u32 v29, 36864, v11
  v_add_u32 v30, 24576, v12
  v_add_u32 v31, 24576, v13
  v_add_u32 v32, 24576, v14
  v_lshrrev_b32 v100, 1, v106
  v_and_b32 v102, 1, v106
  v_lshrrev_b32 v101, 3, v105
  v_xor_b32 v104, v102, v100
  v_xor_b32 v104, v104, v101
  v_lshlrev_b32 v104, 6, v104
  v_lshrrev_b32 v34, 2, v105
  v_xor_b32 v34, v34, v102
  v_lshl_add_u32 v104, v34, 7, v104
  v_lshl_add_u32 v104, v102, 10, v104
  v_and_b32_e64 v34, 3, v105
  v_lshl_add_u32 v34, v34, 4, v104
  v_lshl_add_u32 v103, v102, 4, v105
  s_lshl_b32 s35, s29, 5
  v_add_u32 v104, s35, v103
  v_cmp_gt_u32 vcc, 729, v104
  s_mul_i32 s34, s30, 729
  v_add_u32_e64 v104, s34, v104
  v_mul_u32_u24 v104, 384, v104
  s_mul_i32 s35, s28, 96
  v_lshl_add_u32 v104, v100, 4, v104
  v_add_u32 v104, s35, v104
  v_mov_b32_e64 v33, 0x40000000
  v_cndmask_b32 v33, v33, v104, vcc
  v_bfe_u32 v104, v103, 3, 1
  v_xor_b32 v104, v104, v100
  v_lshlrev_b32 v104, 6, v104
  v_and_b32_e64 v101, 3, v103
  v_lshl_add_u32 v104, v101, 4, v104
  v_lshrrev_b32 v101, 2, v103
  s_and_b32 s35, s28, 1
  v_xor_b32_e64 v101, s35, v101
  v_lshl_add_u32 v26, v101, 7, v104
  v_xor_b32_e64 v101, 1, v101
  v_lshl_add_u32 v27, v101, 7, v104
  s_add_u32 s34, s60, 20480
  v_add_u32 v26, s34, v26
  v_add_u32 v27, s34, v27
  s_mul_i32 s34, s30, 736
  s_lshl_b32 s35, s29, 5
  s_add_u32 s34, s34, s35
  s_lshl_b32 s34, s34, 3
  s_add_u32 s66, s34, 2359296
  v_lshlrev_b32 v24, 3, v105
  v_xor_b32 v104, v100, v102
  v_lshlrev_b32 v104, 7, v104
  v_lshl_add_u32 v104, v102, 10, v104
  v_bfe_u32 v101, v1, 2, 2
  v_lshl_add_u32 v104, v101, 4, v104
  v_and_b32_e64 v101, 1, v1
  v_lshl_add_u32 v104, v101, 3, v104
  v_add_u32_e64 v104, s60, v104
  v_bfe_u32 v101, v1, 1, 1
  v_lshl_add_u32 v22, v101, 6, v104
  v_xor_b32_e64 v101, 1, v101
  v_lshl_add_u32 v104, v101, 6, v104
  v_add_u32 v23, 256, v104
  v_and_b32 v100, 31, v1
  v_lshrrev_b32 v101, 5, v1
  v_lshrrev_b32_e64 v102, 2, v100
  v_bfe_u32 v103, v100, 3, 1
  v_xor_b32 v103, v103, v101
  v_lshlrev_b32 v103, 6, v103
  v_and_b32_e64 v104, 3, v100
  v_lshl_add_u32 v103, v104, 4, v103
  v_add_u32_e64 v103, s60, v103
  v_lshl_add_u32 v20, v102, 7, v103
  v_xor_b32_e64 v102, 1, v102
  v_lshl_add_u32 v21, v102, 7, v103
  v_lshlrev_b32_e64 v102, 9, v101
  v_add_u32 v102, 147456, v102
  v_add_u32 v103, 0, v101
  v_xor_b32 v103, v103, v100
  v_lshl_add_u32 v35, v103, 4, v102
  v_add_u32 v103, 2, v101
  v_xor_b32 v103, v103, v100
  v_lshl_add_u32 v36, v103, 4, v102
  v_add_u32 v103, 4, v101
  v_xor_b32 v103, v103, v100
  v_lshl_add_u32 v37, v103, 4, v102
  v_add_u32 v103, 6, v101
  v_xor_b32 v103, v103, v100
  v_lshl_add_u32 v38, v103, 4, v102
  v_lshlrev_b32_e64 v102, 3, v101
  s_mul_i32 s34, s28, 3072
  s_add_u32 s34, s34, 147456
  v_add_u32 v102, s34, v102
  s_mul_i32 s36, s28, 6
  s_add_u32 s35, s36, 0
  s_and_b32 s35, s35, 7
  v_xor_b32_e64 v103, s35, v100
  v_lshl_add_u32 v39, v103, 4, v102
  s_add_u32 s35, s36, 1
  s_and_b32 s35, s35, 7
  v_xor_b32_e64 v103, s35, v100
  v_lshl_add_u32 v40, v103, 4, v102
  s_add_u32 s35, s36, 2
  s_and_b32 s35, s35, 7
  v_xor_b32_e64 v103, s35, v100
  v_lshl_add_u32 v41, v103, 4, v102
  s_add_u32 s35, s36, 3
  s_and_b32 s35, s35, 7
  v_xor_b32_e64 v103, s35, v100
  v_lshl_add_u32 v42, v103, 4, v102
  s_add_u32 s35, s36, 4
  s_and_b32 s35, s35, 7
  v_xor_b32_e64 v103, s35, v100
  v_lshl_add_u32 v43, v103, 4, v102
  s_add_u32 s35, s36, 5
  s_and_b32 s35, s35, 7
  v_xor_b32_e64 v103, s35, v100
  v_lshl_add_u32 v44, v103, 4, v102
  v_lshlrev_b32 v100, 3, v100
  s_lshl_b32 s34, s28, 8
  s_add_u32 s34, s34, 159744
  v_add_u32 v45, s34, v100
  v_add_u32_e64 v47, s60, v17
  s_add_u32 s36, s28, 1
  s_and_b32 s36, s36, 3
  s_lshl_b32 s34, s36, 8
  s_add_u32 s34, s34, 159744
  v_add_u32_e64 v51, s34, v100
  s_mul_i32 s34, s36, 36864
  s_mul_i32 s35, s28, 6144
  s_add_u32 s34, s34, s35
  v_add_u32 v48, s34, v17
  s_waitcnt vmcnt(0)
  s_barrier
  s_cmp_lg_u32 s28, 0
  s_cbranch_scc1 L_nosig
  v_lshlrev_b32 v62, 12, v1
  s_lshl_b32 s34, s29, 7
  s_add_u32 s34, s34, 4980736
  v_mov_b32 v63, 1
  v_add_u32 v62, s34, v62
  s_mov_b64 exec, 0xff
  buffer_atomic_add v63, v62, s[16:19], 0 offen sc1
  s_mov_b64 exec, -1
L_nosig:
  s_mul_i32 s31, s28, 18432
  s_add_u32 s31, s31, 4718592
  buffer_load_dwordx4 a[48:51], v17, s[16:19], s31 offen offset:0 sc1
  s_add_u32 s36, s28, 2
  s_and_b32 s36, s36, 3
  s_lshl_b32 s34, s36, 8
  s_add_u32 s34, s34, 159744
  buffer_load_dwordx4 a[52:55], v17, s[16:19], s31 offen offset:1024 sc1
  v_add_u32_e64 v52, s34, v100
  s_mul_i32 s34, s36, 36864
  s_mul_i32 s35, s28, 6144
  s_add_u32 s34, s34, s35
  buffer_load_dwordx4 a[56:59], v17, s[16:19], s31 offen offset:2048 sc1
  v_add_u32_e64 v49, s34, v17
  s_add_u32 s36, s28, 3
  s_and_b32 s36, s36, 3
  s_lshl_b32 s34, s36, 8
  buffer_load_dwordx4 a[60:63], v17, s[16:19], s31 offen offset:3072 sc1
  s_add_u32 s34, s34, 159744
  v_add_u32_e64 v53, s34, v100
  s_mul_i32 s34, s36, 36864
  s_mul_i32 s35, s28, 6144
  s_add_u32 s31, s31, 4096
  buffer_load_dwordx4 a[64:67], v17, s[16:19], s31 offen offset:0 sc1
  s_add_u32 s34, s34, s35
  v_add_u32 v50, s34, v17
  v_add_u32 v18, 4096, v17
  v_add_u32 v19, 8192, v17
  buffer_load_dwordx4 a[68:71], v17, s[16:19], s31 offen offset:1024 sc1
  s_add_u32 s36, s29, s28
  s_mov_b32 s52, 99
  s_cmp_ge_u32 s36, 23
  s_cselect_b32 s34, 23, 0
  s_sub_u32 s36, s36, s34
  s_cmp_eq_u32 s36, 22
  s_cselect_b32 s52, 0, s52
  s_mul_i32 s46, s36, 12288
  s_add_u32 s46, s46, s59
  s_add_u32 s36, s36, 4
  buffer_load_dwordx4 a[72:75], v17, s[16:19], s31 offen offset:2048 sc1
  s_cmp_ge_u32 s36, 23
  s_cselect_b32 s34, 23, 0
  s_sub_u32 s36, s36, s34
  s_cmp_eq_u32 s36, 22
  s_cselect_b32 s52, 1, s52
  s_mul_i32 s47, s36, 12288
  s_add_u32 s47, s47, s59
  s_add_u32 s36, s36, 4
  s_cmp_ge_u32 s36, 23
  s_cselect_b32 s34, 23, 0
  s_sub_u32 s36, s36, s34
  s_cmp_eq_u32 s36, 22
  s_cselect_b32 s52, 2, s52
  s_mul_i32 s48, s36, 12288
  s_add_u32 s48, s48, s59
  s_add_u32 s36, s36, 4
  buffer_load_dwordx4 a[76:79], v17, s[16:19], s31 offen offset:3072 sc1
  s_cmp_ge_u32 s36, 23
  s_cselect_b32 s34, 23, 0
  s_sub_u32 s36, s36, s34
  s_cmp_eq_u32 s36, 22
  s_cselect_b32 s52, 3, s52
  s_mul_i32 s49, s36, 12288
  s_add_u32 s49, s49, s59
  s_add_u32 s36, s36, 4
  s_cmp_ge_u32 s36, 23
  s_cselect_b32 s34, 23, 0
  s_sub_u32 s36, s36, s34
  s_cmp_eq_u32 s36, 22
  s_cselect_b32 s52, 4, s52
  s_mul_i32 s50, s36, 12288
  s_add_u32 s50, s50, s59
  s_add_u32 s36, s36, 4
  s_add_u32 s31, s31, 4096
  buffer_load_dwordx4 a[80:83], v17, s[16:19], s31 offen offset:0 sc1
  s_cmp_ge_u32 s36, 23
  s_cselect_b32 s34, 23, 0
  s_sub_u32 s36, s36, s34
  s_cmp_eq_u32 s36, 22
  s_cselect_b32 s52, 5, s52
  s_mul_i32 s51, s36, 12288
  s_add_u32 s51, s51, s59
  s_mul_i32 s64, s28, 18432
  s_add_u32 s64, s64, 4849664
  s_mul_i32 s65, s29, 12288
  buffer_load_dwordx4 a[84:87], v17, s[16:19], s31 offen offset:1024 sc1
  s_add_u32 s65, s65, s59
  s_mul_i32 s34, s28, 3072
  s_add_u32 s65, s65, s34
  v_mov_b32_e64 v112, 0
  buffer_load_dwordx4 a[88:91], v17, s[16:19], s31 offen offset:2048 sc1
  v_mov_b32 v113, 0
  v_mov_b32 v114, 0
  v_mov_b32 v115, 0
  v_mov_b32 v116, 0
  buffer_load_dwordx4 a[92:95], v17, s[16:19], s31 offen offset:3072 sc1
  v_mov_b32 v117, 0
  v_mov_b32 v118, 0
  v_mov_b32 v119, 0
  v_mov_b32 v120, 0
  s_add_u32 s31, s31, 4096
  buffer_load_dwordx4 a[96:99], v17, s[16:19], s31 offen offset:0 sc1
  v_mov_b32 v121, 0
  v_mov_b32 v122, 0
  v_mov_b32 v123, 0
  v_mov_b32 v124, 0
  buffer_load_dwordx4 a[100:103], v17, s[16:19], s31 offen offset:1024 sc1
  v_mov_b32 v125, 0
  v_mov_b32 v126, 0
  v_mov_b32 v127, 0
  v_mov_b32 v54, 0
  buffer_load_dwordx4 a[104:107], v17, s[16:19], s31 offen offset:2048 sc1
  s_mov_b32 s61, 0x4e800000
  s_mov_b32 s62, 0x30800000
  buffer_load_dwordx4 a[108:111], v17, s[16:19], s31 offen offset:3072 sc1
  s_add_u32 s31, s31, 4096
  buffer_load_dwordx4 a[112:115], v17, s[16:19], s31 offen offset:0 sc1
  buffer_load_dwordx4 a[116:119], v17, s[16:19], s31 offen offset:1024 sc1
  s_cmp_lg_u32 s28, 0
  s_cbranch_scc1 L_hwait
  v_min_u32 v62, 22, v1
  v_lshlrev_b32_e64 v62, 7, v62
  s_lshl_b32 s31, s30, 12
  s_add_u32 s31, s31, 4980736
  s_mov_b32 s34, 1048576
L_hpoll:
  buffer_load_dword v63, v62, s[16:19], s31 offen sc1
  s_sub_u32 s34, s34, 1
  s_cmp_eq_u32 s34, 0
  s_cbranch_scc1 L_hwait
  s_waitcnt vmcnt(0)
  v_cmp_gt_u32 vcc, 8, v63
  s_cbranch_vccnz L_hpoll
L_hwait:
  s_barrier
  s_sub_u32 s35, s65, 0
  s_mul_i32 s36, s28, 3072
  s_mov_b32 m0, s36
  s_nop 0
  buffer_load_dwordx4 v17, s[16:19], s35 offen offset:0 sc1 lds
  buffer_load_dwordx4 v17, s[16:19], s35 offen offset:1024 sc1 lds
  buffer_load_dwordx4 v17, s[16:19], s35 offen offset:2048 sc1 lds
  s_cmp_eq_u32 s28, 0
  s_cbranch_scc1 L_s2_w0
  s_add_u32 m0, s60, 0
  s_nop 0
  buffer_load_dwordx4 v17, s[16:19], s46 offen offset:0 sc1 lds
  buffer_load_dwordx4 v17, s[16:19], s46 offen offset:1024 sc1 lds
  buffer_load_dwordx4 v17, s[16:19], s46 offen offset:2048 sc1 lds
  buffer_load_dwordx4 v17, s[16:19], s46 offen offset:3072 sc1 lds
  s_add_u32 m0, s60, 4096
  s_nop 0
  buffer_load_dwordx4 v18, s[16:19], s46 offen offset:0 sc1 lds
  buffer_load_dwordx4 v18, s[16:19], s46 offen offset:1024 sc1 lds
  buffer_load_dwordx4 v18, s[16:19], s46 offen offset:2048 sc1 lds
  buffer_load_dwordx4 v18, s[16:19], s46 offen offset:3072 sc1 lds
  s_add_u32 m0, s60, 8192
  s_nop 0
  buffer_load_dwordx4 v19, s[16:19], s46 offen offset:0 sc1 lds
  buffer_load_dwordx4 v19, s[16:19], s46 offen offset:1024 sc1 lds
  buffer_load_dwordx4 v19, s[16:19], s46 offen offset:2048 sc1 lds
  buffer_load_dwordx4 v19, s[16:19], s46 offen offset:3072 sc1 lds
  s_waitcnt vmcnt(12)
  s_branch L_s2_j
L_s2_w0:
  s_waitcnt vmcnt(0)
L_s2_j:
  s_barrier
  ds_read_b128 a[0:3], v34 offset:0
  ds_read_b128 a[24:27], v34 offset:512
  ds_read_b128 a[4:7], v34 offset:2048
  ds_read_b128 a[28:31], v34 offset:2560
  ds_read_b128 a[8:11], v34 offset:4096
  ds_read_b128 a[32:35], v34 offset:4608
  ds_read_b128 a[12:15], v34 offset:6144
  ds_read_b128 a[36:39], v34 offset:6656
  ds_read_b128 a[16:19], v34 offset:8192
  ds_read_b128 a[40:43], v34 offset:8704
  ds_read_b128 a[20:23], v34 offset:10240
  ds_read_b128 a[44:47], v34 offset:10752
  buffer_load_dwordx2 v[58:59], v24, s[16:19], s66 offen offset:0 sc1
  buffer_load_dwordx2 v[60:61], v24, s[16:19], s66 offen offset:128 sc1
  s_waitcnt lgkmcnt(10)
  v_mfma_f32_16x16x32_bf16 v[232:235], a[48:51], a[0:3], 0
  v_mfma_f32_16x16x32_bf16 v[236:239], a[48:51], a[24:27], 0
  v_mfma_f32_16x16x32_bf16 v[240:243], a[72:75], a[0:3], 0
  v_mfma_f32_16x16x32_bf16 v[244:247], a[72:75], a[24:27], 0
  s_add_u32 m0, s60, 12288
  s_nop 0
  buffer_load_dwordx4 v17, s[16:19], s47 offen offset:0 sc1 lds
  v_mfma_f32_16x16x32_bf16 v[248:251], a[96:99], a[0:3], 0
  v_mfma_f32_16x16x32_bf16 v[252:255], a[96:99], a[24:27], 0
  s_waitcnt lgkmcnt(8)
  v_mfma_f32_16x16x32_bf16 v[232:235], a[52:55], a[4:7], v[232:235]
  v_mfma_f32_16x16x32_bf16 v[236:239], a[52:55], a[28:31], v[236:239]
  v_mfma_f32_16x16x32_bf16 v[240:243], a[76:79], a[4:7], v[240:243]
  v_mfma_f32_16x16x32_bf16 v[244:247], a[76:79], a[28:31], v[244:247]
  buffer_load_dwordx4 v17, s[16:19], s47 offen offset:1024 sc1 lds
  v_mfma_f32_16x16x32_bf16 v[248:251], a[100:103], a[4:7], v[248:251]
  v_mfma_f32_16x16x32_bf16 v[252:255], a[100:103], a[28:31], v[252:255]
  s_waitcnt lgkmcnt(6)
  v_mfma_f32_16x16x32_bf16 v[232:235], a[56:59], a[8:11], v[232:235]
  v_mfma_f32_16x16x32_bf16 v[236:239], a[56:59], a[32:35], v[236:239]
  v_mfma_f32_16x16x32_bf16 v[240:243], a[80:83], a[8:11], v[240:243]
  v_mfma_f32_16x16x32_bf16 v[244:247], a[80:83], a[32:35], v[244:247]
  buffer_load_dwordx4 v17, s[16:19], s47 offen offset:2048 sc1 lds
  v_mfma_f32_16x16x32_bf16 v[248:251], a[104:107], a[8:11], v[248:251]
  v_mfma_f32_16x16x32_bf16 v[252:255], a[104:107], a[32:35], v[252:255]
  s_waitcnt lgkmcnt(4)
  v_mfma_f32_16x16x32_bf16 v[232:235], a[60:63], a[12:15], v[232:235]
  v_mfma_f32_16x16x32_bf16 v[236:239], a[60:63], a[36:39], v[236:239]
  v_mfma_f32_16x16x32_bf16 v[240:243], a[84:87], a[12:15], v[240:243]
  v_mfma_f32_16x16x32_bf16 v[244:247], a[84:87], a[36:39], v[244:247]
  buffer_load_dwordx4 v17, s[16:19], s47 offen offset:3072 sc1 lds
  v_mfma_f32_16x16x32_bf16 v[248:251], a[108:111], a[12:15], v[248:251]
  v_mfma_f32_16x16x32_bf16 v[252:255], a[108:111], a[36:39], v[252:255]
  s_waitcnt lgkmcnt(2)
  v_mfma_f32_16x16x32_bf16 v[232:235], a[64:67], a[16:19], v[232:235]
  v_mfma_f32_16x16x32_bf16 v[236:239], a[64:67], a[40:43], v[236:239]
  v_mfma_f32_16x16x32_bf16 v[240:243], a[88:91], a[16:19], v[240:243]
  v_mfma_f32_16x16x32_bf16 v[244:247], a[88:91], a[40:43], v[244:247]
  s_add_u32 m0, s60, 16384
  s_nop 0
  buffer_load_dwordx4 v18, s[16:19], s47 offen offset:0 sc1 lds
  v_mfma_f32_16x16x32_bf16 v[248:251], a[112:115], a[16:19], v[248:251]
  v_mfma_f32_16x16x32_bf16 v[252:255], a[112:115], a[40:43], v[252:255]
  s_waitcnt lgkmcnt(0)
  v_mfma_f32_16x16x32_bf16 v[232:235], a[68:71], a[20:23], v[232:235]
  v_mfma_f32_16x16x32_bf16 v[236:239], a[68:71], a[44:47], v[236:239]
  v_mfma_f32_16x16x32_bf16 v[240:243], a[92:95], a[20:23], v[240:243]
  v_mfma_f32_16x16x32_bf16 v[244:247], a[92:95], a[44:47], v[244:247]
  buffer_load_dwordx4 v18, s[16:19], s47 offen offset:1024 sc1 lds
  v_mfma_f32_16x16x32_bf16 v[248:251], a[116:119], a[20:23], v[248:251]
  v_mfma_f32_16x16x32_bf16 v[252:255], a[116:119], a[44:47], v[252:255]
  s_nop 2
  v_cvt_pk_bf16_f32 v96, v232, v233
  v_cvt_pk_bf16_f32 v97, v234, v235
  ds_write_b64 v30, v[96:97] offset:0
  v_cvt_pk_bf16_f32 v98, v236, v237
  v_cvt_pk_bf16_f32 v99, v238, v239
  ds_write_b64 v30, v[98:99] offset:256
  v_cvt_pk_bf16_f32 v100, v240, v241
  v_cvt_pk_bf16_f32 v101, v242, v243
  ds_write_b64 v31, v[100:101] offset:0
  v_cvt_pk_bf16_f32 v102, v244, v245
  v_cvt_pk_bf16_f32 v103, v246, v247
  ds_write_b64 v31, v[102:103] offset:256
  v_cvt_pk_bf16_f32 v104, v248, v249
  v_cvt_pk_bf16_f32 v105, v250, v251
  ds_write_b64 v32, v[104:105] offset:0
  v_cvt_pk_bf16_f32 v106, v252, v253
  v_cvt_pk_bf16_f32 v107, v254, v255
  ds_write_b64 v32, v[106:107] offset:256
  s_waitcnt vmcnt(8)
  s_waitcnt lgkmcnt(0)
  s_barrier
  ds_read_b128 a[0:3], v35 offset:0
  ds_read_b128 a[48:51], v20 offset:0
  ds_read_b128 a[4:7], v36 offset:1024
  ds_read_b128 a[52:55], v21 offset:1024
  buffer_load_dwordx4 v18, s[16:19], s47 offen offset:2048 sc1 lds
  ds_read_b128 a[8:11], v37 offset:2048
  ds_read_b128 a[56:59], v20 offset:2048
  ds_read_b128 a[12:15], v38 offset:3072
  ds_read_b128 a[60:63], v21 offset:3072
  buffer_load_dwordx4 v18, s[16:19], s47 offen offset:3072 sc1 lds
  ds_read_b128 a[16:19], v35 offset:4096
  ds_read_b128 a[64:67], v20 offset:4096
  ds_read_b128 a[20:23], v36 offset:5120
  ds_read_b128 a[68:71], v21 offset:5120
  s_add_u32 m0, s60, 20480
  s_nop 0
  buffer_load_dwordx4 v19, s[16:19], s47 offen offset:0 sc1 lds
  ds_read_b128 a[24:27], v37 offset:6144
  ds_read_b128 a[72:75], v20 offset:6144
  ds_read_b128 a[28:31], v38 offset:7168
  ds_read_b128 a[76:79], v21 offset:7168
  buffer_load_dwordx4 v19, s[16:19], s47 offen offset:1024 sc1 lds
  ds_read_b128 a[32:35], v35 offset:8192
  ds_read_b128 a[80:83], v20 offset:8192
  ds_read_b128 a[36:39], v36 offset:9216
  ds_read_b128 a[84:87], v21 offset:9216
  buffer_load_dwordx4 v19, s[16:19], s47 offen offset:2048 sc1 lds
  ds_read_b128 a[40:43], v37 offset:10240
  ds_read_b128 a[88:91], v20 offset:10240
  ds_read_b128 a[44:47], v38 offset:11264
  ds_read_b128 a[92:95], v21 offset:11264
  buffer_load_dwordx4 v19, s[16:19], s47 offen offset:3072 sc1 lds
  s_add_u32 m0, s60, 24576
  s_nop 0
  buffer_load_dwordx4 v17, s[16:19], s48 offen offset:0 sc1 lds
  buffer_load_dwordx4 v17, s[16:19], s48 offen offset:1024 sc1 lds
  buffer_load_dwordx4 v17, s[16:19], s48 offen offset:2048 sc1 lds
  buffer_load_dwordx4 v17, s[16:19], s48 offen offset:3072 sc1 lds
  s_add_u32 m0, s60, 28672
  s_nop 0
  buffer_load_dwordx4 v18, s[16:19], s48 offen offset:0 sc1 lds
  buffer_load_dwordx4 v18, s[16:19], s48 offen offset:1024 sc1 lds
  s_waitcnt lgkmcnt(15)
  v_mfma_f32_32x32x16_bf16 v[64:79], a[48:51], a[0:3], v[112:127]
  s_waitcnt vmcnt(15)
  ds_read_b128 a[48:51], v20 offset:12288
  ds_read_b64_tr_b16 a[96:97], v22 offset:0
  ds_read_b64_tr_b16 a[98:99], v23 offset:0
  v_mfma_f32_32x32x16_bf16 v[64:79], a[52:55], a[4:7], v[64:79]
  ds_read_b128 a[52:55], v21 offset:13312
  ds_read_b64_tr_b16 a[104:105], v22 offset:2048
  ds_read_b64_tr_b16 a[106:107], v23 offset:2048
  v_mfma_f32_32x32x16_bf16 v[64:79], a[56:59], a[8:11], v[64:79]
  ds_read_b128 a[56:59], v20 offset:14336
  ds_read_b64_tr_b16 a[112:113], v22 offset:4096
  ds_read_b64_tr_b16 a[114:115], v23 offset:4096
  buffer_load_dwordx4 v18, s[16:19], s48 offen offset:2048 sc1 lds
  v_mfma_f32_32x32x16_bf16 v[64:79], a[60:63], a[12:15], v[64:79]
  s_waitcnt vmcnt(13)
  ds_read_b128 a[60:63], v21 offset:15360
  ds_read_b64_tr_b16 a[120:121], v22 offset:6144
  ds_read_b64_tr_b16 a[122:123], v23 offset:6144
  s_waitcnt lgkmcnt(15)
  v_mfma_f32_32x32x16_bf16 v[64:79], a[64:67], a[16:19], v[64:79]
  ds_read_b128 a[64:67], v20 offset:16384
  ds_read_b64_tr_b16 a[128:129], v22 offset:8192
  ds_read_b64_tr_b16 a[130:131], v23 offset:8192
  buffer_load_dwordx4 v18, s[16:19], s48 offen offset:3072 sc1 lds
  s_add_u32 m0, s60, 32768
  v_mfma_f32_32x32x16_bf16 v[64:79], a[68:71], a[20:23], v[64:79]
  ds_read_b128 a[68:71], v21 offset:17408
  ds_read_b64_tr_b16 a[136:137], v22 offset:10240
  ds_read_b64_tr_b16 a[138:139], v23 offset:10240
  v_mfma_f32_32x32x16_bf16 v[64:79], a[72:75], a[24:27], v[64:79]
  s_waitcnt vmcnt(11)
  ds_read_b128 a[72:75], v20 offset:18432
  ds_read_b64_tr_b16 a[100:101], v22 offset:512
  ds_read_b64_tr_b16 a[102:103], v23 offset:512
  buffer_load_dwordx4 v19, s[16:19], s48 offen offset:0 sc1 lds
  v_mfma_f32_32x32x16_bf16 v[64:79], a[76:79], a[28:31], v[64:79]
  ds_read_b128 a[76:79], v21 offset:19456
  ds_read_b64_tr_b16 a[108:109], v22 offset:2560
  ds_read_b64_tr_b16 a[110:111], v23 offset:2560
  v_mfma_f32_32x32x16_bf16 v[64:79], a[80:83], a[32:35], v[64:79]
  ds_read_b128 a[80:83], v20 offset:20480
  ds_read_b64_tr_b16 a[116:117], v22 offset:4608
  ds_read_b64_tr_b16 a[118:119], v23 offset:4608
  buffer_load_dwordx4 v19, s[16:19], s48 offen offset:1024 sc1 lds
  v_mfma_f32_32x32x16_bf16 v[64:79], a[84:87], a[36:39], v[64:79]
  s_waitcnt vmcnt(10)
  ds_read_b128 a[84:87], v21 offset:21504
  ds_read_b64_tr_b16 a[124:125], v22 offset:6656
  ds_read_b64_tr_b16 a[126:127], v23 offset:6656
  s_waitcnt lgkmcnt(15)
  v_mfma_f32_32x32x16_bf16 v[64:79], a[88:91], a[40:43], v[64:79]
  ds_read_b128 a[88:91], v20 offset:22528
  ds_read_b64_tr_b16 a[132:133], v22 offset:8704
  ds_read_b64_tr_b16 a[134:135], v23 offset:8704
  buffer_load_dwordx4 v19, s[16:19], s48 offen offset:2048 sc1 lds
  v_mfma_f32_32x32x16_bf16 v[64:79], a[92:95], a[44:47], v[64:79]
  ds_read_b128 a[92:95], v21 offset:23552
  ds_read_b64_tr_b16 a[140:141], v22 offset:10752
  ds_read_b64_tr_b16 a[142:143], v23 offset:10752
  buffer_load_dwordx4 v19, s[16:19], s48 offen offset:3072 sc1 lds
  s_add_u32 m0, s60, 0
  s_waitcnt lgkmcnt(2)
  v_mfma_f32_32x32x16_bf16 v[80:95], a[48:51], a[0:3], v[112:127]
  s_waitcnt vmcnt(9)
  ds_read_b128 a[48:51], v20 offset:24576
  v_mfma_f32_32x32x16_bf16 v[80:95], a[52:55], a[4:7], v[80:95]
  ds_read_b128 a[52:55], v21 offset:25600
  s_waitcnt lgkmcnt(2)
  buffer_load_dwordx4 v17, s[16:19], s49 offen offset:0 sc1 lds
  v_mfma_f32_32x32x16_bf16 v[80:95], a[56:59], a[8:11], v[80:95]
  ds_read_b128 a[56:59], v20 offset:26624
  buffer_load_dwordx4 v17, s[16:19], s49 offen offset:1024 sc1 lds
  v_mfma_f32_32x32x16_bf16 v[80:95], a[60:63], a[12:15], v[80:95]
  s_waitcnt vmcnt(8)
  ds_read_b128 a[60:63], v21 offset:27648
  v_exp_f32 v96, v64
  v_exp_f32_e64 v97, v65
  v_mfma_f32_32x32x16_bf16 v[80:95], a[64:67], a[16:19], v[80:95]
  ds_read_b128 a[64:67], v20 offset:28672
  v_cvt_pk_bf16_f32 v224, v96, v97
  v_exp_f32 v98, v66
  v_exp_f32 v99, v67
  v_add_f32_e64 v56, v96, v97
  v_mfma_f32_32x32x16_bf16 v[80:95], a[68:71], a[20:23], v[80:95]
  ds_read_b128 a[68:71], v21 offset:29696
  v_cvt_pk_bf16_f32 v225, v98, v99
  v_exp_f32 v100, v68
  v_exp_f32 v101, v69
  v_add_f32_e64 v57, v98, v99
  v_mfma_f32_32x32x16_bf16 v[80:95], a[72:75], a[24:27], v[80:95]
  s_waitcnt vmcnt(5)
  ds_read_b128 a[72:75], v20 offset:30720
  v_exp_f32 v102, v70
  v_add_f32_e64 v56, v56, v100
  v_cvt_pk_bf16_f32 v226, v100, v101
  v_exp_f32 v103, v71
  v_add_f32 v57, v57, v101
  buffer_load_dwordx4 v17, s[16:19], s49 offen offset:2048 sc1 lds
  v_exp_f32 v104, v72
  v_add_f32 v56, v56, v102
  v_mfma_f32_32x32x16_bf16 v[80:95], a[76:79], a[28:31], v[80:95]
  ds_read_b128 a[76:79], v21 offset:31744
  v_exp_f32 v105, v73
  v_add_f32 v57, v57, v103
  v_cvt_pk_bf16_f32 v227, v102, v103
  v_exp_f32 v106, v74
  v_add_f32 v56, v56, v104
  v_mfma_f32_32x32x16_bf16 v[80:95], a[80:83], a[32:35], v[80:95]
  ds_read_b128 a[80:83], v20 offset:32768
  v_exp_f32 v107, v75
  v_add_f32 v57, v57, v105
  v_cvt_pk_bf16_f32 v228, v104, v105
  s_cmp_eq_u32 s52, 0
  s_cbranch_scc0 L_nm0
  v_mov_b32 v77, 0xff800000
  v_mov_b32 v78, 0xff800000
  v_mov_b32 v79, 0xff800000
  v_mov_b32 v62, 0xff800000
  v_cndmask_b32 v76, v76, v62, s[44:45]
L_nm0:
  v_exp_f32 v108, v76
  v_add_f32 v56, v56, v106
  buffer_load_dwordx4 v17, s[16:19], s49 offen offset:3072 sc1 lds
  s_add_u32 m0, s60, 4096
  v_mfma_f32_32x32x16_bf16 v[80:95], a[84:87], a[36:39], v[80:95]
  s_waitcnt vmcnt(4)
  ds_read_b128 a[84:87], v21 offset:33792
  v_exp_f32 v109, v77
  v_add_f32 v57, v57, v107
  v_exp_f32 v110, v78
  v_add_f32_e64 v56, v56, v108
  v_cvt_pk_bf16_f32 v229, v106, v107
  v_exp_f32 v111, v79
  v_add_f32 v57, v57, v109
  v_mfma_f32_32x32x16_bf16 v[80:95], a[88:91], a[40:43], v[80:95]
  ds_read_b128 a[88:91], v20 offset:34816
  v_add_f32 v56, v56, v110
  v_add_f32 v57, v57, v111
  buffer_load_dwordx4 v18, s[16:19], s49 offen offset:0 sc1 lds
  v_cvt_pk_bf16_f32 v230, v108, v109
  v_cvt_pk_bf16_f32 v231, v110, v111
  v_mfma_f32_32x32x16_bf16 v[80:95], a[92:95], a[44:47], v[80:95]
  ds_read_b128 a[92:95], v21 offset:35840
  v_add_f32 v56, v56, v57
  v_cmp_nge_f32 vcc, s61, v56
  v_cmp_gt_f32 s[34:35], s62, v56
  buffer_load_dwordx4 v18, s[16:19], s49 offen offset:1024 sc1 lds
  s_or_b64 vcc, vcc, s[34:35]
  s_cbranch_vccnz L_rare_0
L_back_0:
  v_mfma_f32_32x32x16_bf16 v[128:143], a[96:99], v[224:227], 0
  ds_read_b64_tr_b16 a[96:97], v22 offset:12288
  ds_read_b64_tr_b16 a[98:99], v23 offset:12288
  v_add_f32_e64 v54, v54, v56
  buffer_load_dwordx4 v18, s[16:19], s49 offen offset:2048 sc1 lds
  v_mfma_f32_32x32x16_bf16 v[144:159], a[104:107], v[224:227], 0
  ds_read_b64_tr_b16 a[104:105], v22 offset:14336
  ds_read_b64_tr_b16 a[106:107], v23 offset:14336
  buffer_load_dwordx4 v18, s[16:19], s49 offen offset:3072 sc1 lds
  s_add_u32 m0, s60, 8192
  v_mfma_f32_32x32x16_bf16 v[160:175], a[112:115], v[224:227], 0
  ds_read_b64_tr_b16 a[112:113], v22 offset:16384
  ds_read_b64_tr_b16 a[114:115], v23 offset:16384
  v_exp_f32_e64 v96, v80
  v_mfma_f32_32x32x16_bf16 v[176:191], a[120:123], v[224:227], 0
  ds_read_b64_tr_b16 a[120:121], v22 offset:18432
  ds_read_b64_tr_b16 a[122:123], v23 offset:18432
  v_exp_f32_e64 v97, v81
  v_mfma_f32_32x32x16_bf16 v[192:207], a[128:131], v[224:227], 0
  ds_read_b64_tr_b16 a[128:129], v22 offset:20480
  ds_read_b64_tr_b16 a[130:131], v23 offset:20480
  v_exp_f32_e64 v98, v82
  buffer_load_dwordx4 v19, s[16:19], s49 offen offset:0 sc1 lds
  v_mfma_f32_32x32x16_bf16 v[208:223], a[136:139], v[224:227], 0
  ds_read_b64_tr_b16 a[136:137], v22 offset:22528
  ds_read_b64_tr_b16 a[138:139], v23 offset:22528
  v_exp_f32 v99, v83
  v_add_f32 v56, v96, v97
  v_mfma_f32_32x32x16_bf16 v[128:143], a[100:103], v[228:231], v[128:143]
  ds_read_b64_tr_b16 a[100:101], v22 offset:12800
  ds_read_b64_tr_b16 a[102:103], v23 offset:12800
  buffer_load_dwordx4 v19, s[16:19], s49 offen offset:1024 sc1 lds
  v_exp_f32_e64 v100, v84
  v_mfma_f32_32x32x16_bf16 v[144:159], a[108:111], v[228:231], v[144:159]
  ds_read_b64_tr_b16 a[108:109], v22 offset:14848
  ds_read_b64_tr_b16 a[110:111], v23 offset:14848
  v_cvt_pk_bf16_f32 v224, v96, v97
  v_exp_f32 v101, v85
  v_add_f32 v57, v98, v99
  v_mfma_f32_32x32x16_bf16 v[160:175], a[116:119], v[228:231], v[160:175]
  ds_read_b64_tr_b16 a[116:117], v22 offset:16896
  ds_read_b64_tr_b16 a[118:119], v23 offset:16896
  buffer_load_dwordx4 v19, s[16:19], s49 offen offset:2048 sc1 lds
  v_exp_f32 v102, v86
  v_add_f32 v56, v56, v100
  v_cvt_pk_bf16_f32 v225, v98, v99
  v_mfma_f32_32x32x16_bf16 v[176:191], a[124:127], v[228:231], v[176:191]
  ds_read_b64_tr_b16 a[124:125], v22 offset:18944
  ds_read_b64_tr_b16 a[126:127], v23 offset:18944
  v_exp_f32 v103, v87
  v_add_f32 v57, v57, v101
  buffer_load_dwordx4 v19, s[16:19], s49 offen offset:3072 sc1 lds
  s_add_u32 m0, s60, 12288
  v_mfma_f32_32x32x16_bf16 v[192:207], a[132:135], v[228:231], v[192:207]
  ds_read_b64_tr_b16 a[132:133], v22 offset:20992
  ds_read_b64_tr_b16 a[134:135], v23 offset:20992
  v_cvt_pk_bf16_f32 v226, v100, v101
  v_exp_f32 v104, v88
  v_add_f32 v56, v56, v102
  v_mfma_f32_32x32x16_bf16 v[208:223], a[140:143], v[228:231], v[208:223]
  ds_read_b64_tr_b16 a[140:141], v22 offset:23040
  ds_read_b64_tr_b16 a[142:143], v23 offset:23040
  v_exp_f32 v105, v89
  v_add_f32 v57, v57, v103
  v_cvt_pk_bf16_f32 v227, v102, v103
  s_waitcnt lgkmcnt(15)
  v_mfma_f32_32x32x16_bf16 v[64:79], a[48:51], a[0:3], v[112:127]
  s_waitcnt vmcnt(9)
  ds_read_b128 a[48:51], v20 offset:0
  v_exp_f32 v106, v90
  v_add_f32 v56, v56, v104
  v_mfma_f32_32x32x16_bf16 v[64:79], a[52:55], a[4:7], v[64:79]
  ds_read_b128 a[52:55], v21 offset:1024
  v_cvt_pk_bf16_f32 v228, v104, v105
  s_waitcnt lgkmcnt(2)
  buffer_load_dwordx4 v17, s[16:19], s50 offen offset:0 sc1 lds
  v_mfma_f32_32x32x16_bf16 v[64:79], a[56:59], a[8:11], v[64:79]
  ds_read_b128 a[56:59], v20 offset:2048
  v_exp_f32 v107, v91
  v_add_f32_e64 v57, v57, v105
  v_mfma_f32_32x32x16_bf16 v[64:79], a[60:63], a[12:15], v[64:79]
  s_waitcnt vmcnt(7)
  ds_read_b128 a[60:63], v21 offset:3072
  s_cmp_eq_u32 s52, 1
  s_cbranch_scc0 L_nm1
  v_mov_b32 v93, 0xff800000
  v_mov_b32 v94, 0xff800000
  v_mov_b32 v95, 0xff800000
  v_mov_b32 v62, 0xff800000
  v_cndmask_b32 v92, v92, v62, s[44:45]
L_nm1:
  v_exp_f32 v108, v92
  v_add_f32_e64 v56, v56, v106
  v_mfma_f32_32x32x16_bf16 v[64:79], a[64:67], a[16:19], v[64:79]
  ds_read_b128 a[64:67], v20 offset:4096
  buffer_load_dwordx4 v17, s[16:19], s50 offen offset:1024 sc1 lds
  v_cvt_pk_bf16_f32 v229, v106, v107
  v_mfma_f32_32x32x16_bf16 v[64:79], a[68:71], a[20:23], v[64:79]
  ds_read_b128 a[68:71], v21 offset:5120
  v_exp_f32 v109, v93
  v_add_f32 v57, v57, v107
  v_mfma_f32_32x32x16_bf16 v[64:79], a[72:75], a[24:27], v[64:79]
  s_waitcnt vmcnt(5)
  ds_read_b128 a[72:75], v20 offset:6144
  buffer_load_dwordx4 v17, s[16:19], s50 offen offset:2048 sc1 lds
  v_exp_f32 v110, v94
  v_add_f32_e64 v56, v56, v108
  v_mfma_f32_32x32x16_bf16 v[64:79], a[76:79], a[28:31], v[64:79]
  ds_read_b128 a[76:79], v21 offset:7168
  v_exp_f32 v111, v95
  v_add_f32 v57, v57, v109
  v_mfma_f32_32x32x16_bf16 v[64:79], a[80:83], a[32:35], v[64:79]
  ds_read_b128 a[80:83], v20 offset:8192
  buffer_load_dwordx4 v17, s[16:19], s50 offen offset:3072 sc1 lds
  s_add_u32 m0, s60, 16384
  v_cvt_pk_bf16_f32 v230, v108, v109
  v_add_f32_e64 v56, v56, v110
  v_mfma_f32_32x32x16_bf16 v[64:79], a[84:87], a[36:39], v[64:79]
  s_waitcnt vmcnt(4)
  ds_read_b128 a[84:87], v21 offset:9216
  v_add_f32 v57, v57, v111
  buffer_load_dwordx4 v18, s[16:19], s50 offen offset:0 sc1 lds
  v_mfma_f32_32x32x16_bf16 v[64:79], a[88:91], a[40:43], v[64:79]
  ds_read_b128 a[88:91], v20 offset:10240
  v_add_f32_e64 v56, v56, v57
  v_cvt_pk_bf16_f32 v231, v110, v111
  v_mfma_f32_32x32x16_bf16 v[64:79], a[92:95], a[44:47], v[64:79]
  ds_read_b128 a[92:95], v21 offset:11264
  buffer_load_dwordx4 v18, s[16:19], s50 offen offset:1024 sc1 lds
  v_cmp_nge_f32 vcc, s61, v56
  s_cbranch_vccnz L_rare_1
L_back_1:
  v_mfma_f32_32x32x16_bf16 v[128:143], a[96:99], v[224:227], v[128:143]
  ds_read_b64_tr_b16 a[96:97], v22 offset:24576
  ds_read_b64_tr_b16 a[98:99], v23 offset:24576
  v_add_f32_e64 v54, v54, v56
  buffer_load_dwordx4 v18, s[16:19], s50 offen offset:2048 sc1 lds
  v_mfma_f32_32x32x16_bf16 v[144:159], a[104:107], v[224:227], v[144:159]
  ds_read_b64_tr_b16 a[104:105], v22 offset:26624
  ds_read_b64_tr_b16 a[106:107], v23 offset:26624
  buffer_load_dwordx4 v18, s[16:19], s50 offen offset:3072 sc1 lds
  s_add_u32 m0, s60, 20480
  v_mfma_f32_32x32x16_bf16 v[160:175], a[112:115], v[224:227], v[160:175]
  ds_read_b64_tr_b16 a[112:113], v22 offset:28672
  ds_read_b64_tr_b16 a[114:115], v23 offset:28672
  v_exp_f32_e64 v96, v64
  v_mfma_f32_32x32x16_bf16 v[176:191], a[120:123], v[224:227], v[176:191]
  ds_read_b64_tr_b16 a[120:121], v22 offset:30720
  ds_read_b64_tr_b16 a[122:123], v23 offset:30720
  v_exp_f32_e64 v97, v65
  v_mfma_f32_32x32x16_bf16 v[192:207], a[128:131], v[224:227], v[192:207]
  ds_read_b64_tr_b16 a[128:129], v22 offset:32768
  ds_read_b64_tr_b16 a[130:131], v23 offset:32768
  v_exp_f32_e64 v98, v66
  buffer_load_dwordx4 v19, s[16:19], s50 offen offset:0 sc1 lds
  v_mfma_f32_32x32x16_bf16 v[208:223], a[136:139], v[224:227], v[208:223]
  ds_read_b64_tr_b16 a[136:137], v22 offset:34816
  ds_read_b64_tr_b16 a[138:139], v23 offset:34816
  v_exp_f32 v99, v67
  v_add_f32 v56, v96, v97
  v_mfma_f32_32x32x16_bf16 v[128:143], a[100:103], v[228:231], v[128:143]
  ds_read_b64_tr_b16 a[100:101], v22 offset:25088
  ds_read_b64_tr_b16 a[102:103], v23 offset:25088
  buffer_load_dwordx4 v19, s[16:19], s50 offen offset:1024 sc1 lds
  v_exp_f32_e64 v100, v68
  v_mfma_f32_32x32x16_bf16 v[144:159], a[108:111], v[228:231], v[144:159]
  ds_read_b64_tr_b16 a[108:109], v22 offset:27136
  ds_read_b64_tr_b16 a[110:111], v23 offset:27136
  v_cvt_pk_bf16_f32 v224, v96, v97
  v_exp_f32 v101, v69
  v_add_f32 v57, v98, v99
  v_mfma_f32_32x32x16_bf16 v[160:175], a[116:119], v[228:231], v[160:175]
  ds_read_b64_tr_b16 a[116:117], v22 offset:29184
  ds_read_b64_tr_b16 a[118:119], v23 offset:29184
  buffer_load_dwordx4 v19, s[16:19], s50 offen offset:2048 sc1 lds
  v_exp_f32 v102, v70
  v_add_f32 v56, v56, v100
  v_cvt_pk_bf16_f32 v225, v98, v99
  v_mfma_f32_32x32x16_bf16 v[176:191], a[124:127], v[228:231], v[176:191]
  ds_read_b64_tr_b16 a[124:125], v22 offset:31232
  ds_read_b64_tr_b16 a[126:127], v23 offset:31232
  v_exp_f32 v103, v71
  v_add_f32 v57, v57, v101
  buffer_load_dwordx4 v19, s[16:19], s50 offen offset:3072 sc1 lds
  s_add_u32 m0, s60, 24576
  v_mfma_f32_32x32x16_bf16 v[192:207], a[132:135], v[228:231], v[192:207]
  ds_read_b64_tr_b16 a[132:133], v22 offset:33280
  ds_read_b64_tr_b16 a[134:135], v23 offset:33280
  v_cvt_pk_bf16_f32 v226, v100, v101
  v_exp_f32 v104, v72
  v_add_f32 v56, v56, v102
  v_mfma_f32_32x32x16_bf16 v[208:223], a[140:143], v[228:231], v[208:223]
  ds_read_b64_tr_b16 a[140:141], v22 offset:35328
  ds_read_b64_tr_b16 a[142:143], v23 offset:35328
  v_exp_f32 v105, v73
  v_add_f32 v57, v57, v103
  v_cvt_pk_bf16_f32 v227, v102, v103
  s_waitcnt lgkmcnt(15)
  v_mfma_f32_32x32x16_bf16 v[80:95], a[48:51], a[0:3], v[112:127]
  s_waitcnt vmcnt(9)
  ds_read_b128 a[48:51], v20 offset:12288
  v_exp_f32 v106, v74
  v_add_f32 v56, v56, v104
  v_mfma_f32_32x32x16_bf16 v[80:95], a[52:55], a[4:7], v[80:95]
  ds_read_b128 a[52:55], v21 offset:13312
  v_cvt_pk_bf16_f32 v228, v104, v105
  s_waitcnt lgkmcnt(2)
  buffer_load_dwordx4 v17, s[16:19], s51 offen offset:0 sc1 lds
  v_mfma_f32_32x32x16_bf16 v[80:95], a[56:59], a[8:11], v[80:95]
  ds_read_b128 a[56:59], v20 offset:14336
  v_exp_f32 v107, v75
  v_add_f32_e64 v57, v57, v105
  v_mfma_f32_32x32x16_bf16 v[80:95], a[60:63], a[12:15], v[80:95]
  s_waitcnt vmcnt(7)
  ds_read_b128 a[60:63], v21 offset:15360
  s_cmp_eq_u32 s52, 2
  s_cbranch_scc0 L_nm2
  v_mov_b32 v77, 0xff800000
  v_mov_b32 v78, 0xff800000
  v_mov_b32 v79, 0xff800000
  v_mov_b32 v62, 0xff800000
  v_cndmask_b32 v76, v76, v62, s[44:45]
L_nm2:
  v_exp_f32 v108, v76
  v_add_f32_e64 v56, v56, v106
  v_mfma_f32_32x32x16_bf16 v[80:95], a[64:67], a[16:19], v[80:95]
  ds_read_b128 a[64:67], v20 offset:16384
  buffer_load_dwordx4 v17, s[16:19], s51 offen offset:1024 sc1 lds
  v_cvt_pk_bf16_f32 v229, v106, v107
  v_mfma_f32_32x32x16_bf16 v[80:95], a[68:71], a[20:23], v[80:95]
  ds_read_b128 a[68:71], v21 offset:17408
  v_exp_f32 v109, v77
  v_add_f32 v57, v57, v107
  v_mfma_f32_32x32x16_bf16 v[80:95], a[72:75], a[24:27], v[80:95]
  s_waitcnt vmcnt(5)
  ds_read_b128 a[72:75], v20 offset:18432
  buffer_load_dwordx4 v17, s[16:19], s51 offen offset:2048 sc1 lds
  v_exp_f32 v110, v78
  v_add_f32_e64 v56, v56, v108
  v_mfma_f32_32x32x16_bf16 v[80:95], a[76:79], a[28:31], v[80:95]
  ds_read_b128 a[76:79], v21 offset:19456
  v_exp_f32 v111, v79
  v_add_f32 v57, v57, v109
  v_mfma_f32_32x32x16_bf16 v[80:95], a[80:83], a[32:35], v[80:95]
  ds_read_b128 a[80:83], v20 offset:20480
  buffer_load_dwordx4 v17, s[16:19], s51 offen offset:3072 sc1 lds
  s_add_u32 m0, s60, 28672
  v_cvt_pk_bf16_f32 v230, v108, v109
  v_add_f32_e64 v56, v56, v110
  v_mfma_f32_32x32x16_bf16 v[80:95], a[84:87], a[36:39], v[80:95]
  s_waitcnt vmcnt(4)
  ds_read_b128 a[84:87], v21 offset:21504
  v_add_f32 v57, v57, v111
  buffer_load_dwordx4 v18, s[16:19], s51 offen offset:0 sc1 lds
  v_mfma_f32_32x32x16_bf16 v[80:95], a[88:91], a[40:43], v[80:95]
  ds_read_b128 a[88:91], v20 offset:22528
  v_add_f32_e64 v56, v56, v57
  v_cvt_pk_bf16_f32 v231, v110, v111
  v_mfma_f32_32x32x16_bf16 v[80:95], a[92:95], a[44:47], v[80:95]
  ds_read_b128 a[92:95], v21 offset:23552
  buffer_load_dwordx4 v18, s[16:19], s51 offen offset:1024 sc1 lds
  v_cmp_nge_f32 vcc, s61, v56
  s_cbranch_vccnz L_rare_2
L_back_2:
  v_mfma_f32_32x32x16_bf16 v[128:143], a[96:99], v[224:227], v[128:143]
  ds_read_b64_tr_b16 a[96:97], v22 offset:0
  ds_read_b64_tr_b16 a[98:99], v23 offset:0
  v_add_f32_e64 v54, v54, v56
  buffer_load_dwordx4 v18, s[16:19], s51 offen offset:2048 sc1 lds
  v_mfma_f32_32x32x16_bf16 v[144:159], a[104:107], v[224:227], v[144:159]
  ds_read_b64_tr_b16 a[104:105], v22 offset:2048
  ds_read_b64_tr_b16 a[106:107], v23 offset:2048
  buffer_load_dwordx4 v18, s[16:19], s51 offen offset:3072 sc1 lds
  s_add_u32 m0, s60, 32768
  v_mfma_f32_32x32x16_bf16 v[160:175], a[112:115], v[224:227], v[160:175]
  ds_read_b64_tr_b16 a[112:113], v22 offset:4096
  ds_read_b64_tr_b16 a[114:115], v23 offset:4096
  v_exp_f32_e64 v96, v80
  v_mfma_f32_32x32x16_bf16 v[176:191], a[120:123], v[224:227], v[176:191]
  ds_read_b64_tr_b16 a[120:121], v22 offset:6144
  ds_read_b64_tr_b16 a[122:123], v23 offset:6144
  v_exp_f32_e64 v97, v81
  v_mfma_f32_32x32x16_bf16 v[192:207], a[128:131], v[224:227], v[192:207]
  ds_read_b64_tr_b16 a[128:129], v22 offset:8192
  ds_read_b64_tr_b16 a[130:131], v23 offset:8192
  v_exp_f32_e64 v98, v82
  buffer_load_dwordx4 v19, s[16:19], s51 offen offset:0 sc1 lds
  v_mfma_f32_32x32x16_bf16 v[208:223], a[136:139], v[224:227], v[208:223]
  ds_read_b64_tr_b16 a[136:137], v22 offset:10240
  ds_read_b64_tr_b16 a[138:139], v23 offset:10240
  v_exp_f32 v99, v83
  v_add_f32 v56, v96, v97
  v_mfma_f32_32x32x16_bf16 v[128:143], a[100:103], v[228:231], v[128:143]
  ds_read_b64_tr_b16 a[100:101], v22 offset:512
  ds_read_b64_tr_b16 a[102:103], v23 offset:512
  buffer_load_dwordx4 v19, s[16:19], s51 offen offset:1024 sc1 lds
  v_exp_f32_e64 v100, v84
  v_mfma_f32_32x32x16_bf16 v[144:159], a[108:111], v[228:231], v[144:159]
  ds_read_b64_tr_b16 a[108:109], v22 offset:2560
  ds_read_b64_tr_b16 a[110:111], v23 offset:2560
  v_cvt_pk_bf16_f32 v224, v96, v97
  v_exp_f32 v101, v85
  v_add_f32 v57, v98, v99
  v_mfma_f32_32x32x16_bf16 v[160:175], a[116:119], v[228:231], v[160:175]
  ds_read_b64_tr_b16 a[116:117], v22 offset:4608
  ds_read_b64_tr_b16 a[118:119], v23 offset:4608
  buffer_load_dwordx4 v19, s[16:19], s51 offen offset:2048 sc1 lds
  v_exp_f32 v102, v86
  v_add_f32 v56, v56, v100
  v_cvt_pk_bf16_f32 v225, v98, v99
  v_mfma_f32_32x32x16_bf16 v[176:191], a[124:127], v[228:231], v[176:191]
  ds_read_b64_tr_b16 a[124:125], v22 offset:6656
  ds_read_b64_tr_b16 a[126:127], v23 offset:6656
  v_exp_f32 v103, v87
  v_add_f32 v57, v57, v101
  buffer_load_dwordx4 v19, s[16:19], s51 offen offset:3072 sc1 lds
  s_add_u32 m0, s60, 0
  v_mfma_f32_32x32x16_bf16 v[192:207], a[132:135], v[228:231], v[192:207]
  ds_read_b64_tr_b16 a[132:133], v22 offset:8704
  ds_read_b64_tr_b16 a[134:135], v23 offset:8704
  v_cvt_pk_bf16_f32 v226, v100, v101
  v_exp_f32 v104, v88
  v_add_f32_e64 v56, v56, v102
  v_mfma_f32_32x32x16_bf16 v[208:223], a[140:143], v[228:231], v[208:223]
  ds_read_b64_tr_b16 a[140:141], v22 offset:10752
  ds_read_b64_tr_b16 a[142:143], v23 offset:10752
  v_exp_f32 v105, v89
  v_add_f32 v57, v57, v103
  v_cvt_pk_bf16_f32 v227, v102, v103
  s_waitcnt lgkmcnt(15)
  v_mfma_f32_32x32x16_bf16 v[64:79], a[48:51], a[0:3], v[112:127]
  s_waitcnt vmcnt(9)
  ds_read_b128 a[48:51], v20 offset:24576
  v_exp_f32 v106, v90
  v_add_f32 v56, v56, v104
  v_mfma_f32_32x32x16_bf16 v[64:79], a[52:55], a[4:7], v[64:79]
  ds_read_b128 a[52:55], v21 offset:25600
  v_cvt_pk_bf16_f32 v228, v104, v105
  s_waitcnt lgkmcnt(2)
  buffer_load_dwordx4 v17, s[16:19], s64 offen offset:0 sc1 lds
  v_mfma_f32_32x32x16_bf16 v[64:79], a[56:59], a[8:11], v[64:79]
  ds_read_b128 a[56:59], v20 offset:26624
  v_exp_f32 v107, v91
  v_add_f32_e64 v57, v57, v105
  v_mfma_f32_32x32x16_bf16 v[64:79], a[60:63], a[12:15], v[64:79]
  s_waitcnt vmcnt(7)
  ds_read_b128 a[60:63], v21 offset:27648
  s_cmp_eq_u32 s52, 3
  s_cbranch_scc0 L_nm3
  v_mov_b32 v93, 0xff800000
  v_mov_b32 v94, 0xff800000
  v_mov_b32 v95, 0xff800000
  v_mov_b32 v62, 0xff800000
  v_cndmask_b32 v92, v92, v62, s[44:45]
L_nm3:
  v_exp_f32 v108, v92
  v_add_f32_e64 v56, v56, v106
  v_mfma_f32_32x32x16_bf16 v[64:79], a[64:67], a[16:19], v[64:79]
  ds_read_b128 a[64:67], v20 offset:28672
  buffer_load_dwordx4 v17, s[16:19], s64 offen offset:1024 sc1 lds
  v_cvt_pk_bf16_f32 v229, v106, v107
  v_mfma_f32_32x32x16_bf16 v[64:79], a[68:71], a[20:23], v[64:79]
  ds_read_b128 a[68:71], v21 offset:29696
  v_exp_f32 v109, v93
  v_add_f32 v57, v57, v107
  v_mfma_f32_32x32x16_bf16 v[64:79], a[72:75], a[24:27], v[64:79]
  s_waitcnt vmcnt(5)
  ds_read_b128 a[72:75], v20 offset:30720
  buffer_load_dwordx4 v17, s[16:19], s64 offen offset:2048 sc1 lds
  v_exp_f32 v110, v94
  v_add_f32_e64 v56, v56, v108
  v_mfma_f32_32x32x16_bf16 v[64:79], a[76:79], a[28:31], v[64:79]
  ds_read_b128 a[76:79], v21 offset:31744
  v_exp_f32 v111, v95
  v_add_f32 v57, v57, v109
  v_mfma_f32_32x32x16_bf16 v[64:79], a[80:83], a[32:35], v[64:79]
  ds_read_b128 a[80:83], v20 offset:32768
  buffer_load_dwordx4 v17, s[16:19], s64 offen offset:3072 sc1 lds
  s_add_u32 m0, s60, 4096
  v_cvt_pk_bf16_f32 v230, v108, v109
  v_add_f32_e64 v56, v56, v110
  v_mfma_f32_32x32x16_bf16 v[64:79], a[84:87], a[36:39], v[64:79]
  s_waitcnt vmcnt(4)
  ds_read_b128 a[84:87], v21 offset:33792
  v_add_f32 v57, v57, v111
  buffer_load_dwordx4 v18, s[16:19], s64 offen offset:0 sc1 lds
  v_mfma_f32_32x32x16_bf16 v[64:79], a[88:91], a[40:43], v[64:79]
  ds_read_b128 a[88:91], v20 offset:34816
  v_add_f32_e64 v56, v56, v57
  v_cvt_pk_bf16_f32 v231, v110, v111
  v_mfma_f32_32x32x16_bf16 v[64:79], a[92:95], a[44:47], v[64:79]
  ds_read_b128 a[92:95], v21 offset:35840
  buffer_load_dwordx4 v18, s[16:19], s64 offen offset:1024 sc1 lds
  v_cmp_nge_f32 vcc, s61, v56
  s_cbranch_vccnz L_rare_3
L_back_3:
  v_mfma_f32_32x32x16_bf16 v[128:143], a[96:99], v[224:227], v[128:143]
  ds_read_b64_tr_b16 a[96:97], v22 offset:12288
  ds_read_b64_tr_b16 a[98:99], v23 offset:12288
  v_add_f32_e64 v54, v54, v56
  buffer_load_dwordx4 v18, s[16:19], s64 offen offset:2048 sc1 lds
  v_mfma_f32_32x32x16_bf16 v[144:159], a[104:107], v[224:227], v[144:159]
  ds_read_b64_tr_b16 a[104:105], v22 offset:14336
  ds_read_b64_tr_b16 a[106:107], v23 offset:14336
  buffer_load_dwordx4 v18, s[16:19], s64 offen offset:3072 sc1 lds
  s_add_u32 m0, s60, 8192
  v_mfma_f32_32x32x16_bf16 v[160:175], a[112:115], v[224:227], v[160:175]
  ds_read_b64_tr_b16 a[112:113], v22 offset:16384
  ds_read_b64_tr_b16 a[114:115], v23 offset:16384
  v_exp_f32_e64 v96, v64
  v_mfma_f32_32x32x16_bf16 v[176:191], a[120:123], v[224:227], v[176:191]
  ds_read_b64_tr_b16 a[120:121], v22 offset:18432
  ds_read_b64_tr_b16 a[122:123], v23 offset:18432
  v_exp_f32_e64 v97, v65
  v_mfma_f32_32x32x16_bf16 v[192:207], a[128:131], v[224:227], v[192:207]
  ds_read_b64_tr_b16 a[128:129], v22 offset:20480
  ds_read_b64_tr_b16 a[130:131], v23 offset:20480
  v_exp_f32_e64 v98, v66
  buffer_load_dwordx4 v19, s[16:19], s64 offen offset:0 sc1 lds
  v_mfma_f32_32x32x16_bf16 v[208:223], a[136:139], v[224:227], v[208:223]
  ds_read_b64_tr_b16 a[136:137], v22 offset:22528
  ds_read_b64_tr_b16 a[138:139], v23 offset:22528
  v_exp_f32 v99, v67
  v_add_f32 v56, v96, v97
  v_mfma_f32_32x32x16_bf16 v[128:143], a[100:103], v[228:231], v[128:143]
  ds_read_b64_tr_b16 a[100:101], v22 offset:12800
  ds_read_b64_tr_b16 a[102:103], v23 offset:12800
  buffer_load_dwordx4 v19, s[16:19], s64 offen offset:1024 sc1 lds
  v_exp_f32_e64 v100, v68
  v_mfma_f32_32x32x16_bf16 v[144:159], a[108:111], v[228:231], v[144:159]
  ds_read_b64_tr_b16 a[108:109], v22 offset:14848
  ds_read_b64_tr_b16 a[110:111], v23 offset:14848
  v_cvt_pk_bf16_f32 v224, v96, v97
  v_exp_f32 v101, v69
  v_add_f32 v57, v98, v99
  v_mfma_f32_32x32x16_bf16 v[160:175], a[116:119], v[228:231], v[160:175]
  ds_read_b64_tr_b16 a[116:117], v22 offset:16896
  ds_read_b64_tr_b16 a[118:119], v23 offset:16896
  buffer_load_dwordx4 v19, s[16:19], s64 offen offset:2048 sc1 lds
  v_exp_f32 v102, v70
  v_add_f32 v56, v56, v100
  v_cvt_pk_bf16_f32 v225, v98, v99
  v_mfma_f32_32x32x16_bf16 v[176:191], a[124:127], v[228:231], v[176:191]
  ds_read_b64_tr_b16 a[124:125], v22 offset:18944
  ds_read_b64_tr_b16 a[126:127], v23 offset:18944
  v_exp_f32 v103, v71
  v_add_f32 v57, v57, v101
  buffer_load_dwordx4 v19, s[16:19], s64 offen offset:3072 sc1 lds
  s_add_u32 m0, s60, 12288
  s_add_u32 s36, s64, 12288
  v_mfma_f32_32x32x16_bf16 v[192:207], a[132:135], v[228:231], v[192:207]
  ds_read_b64_tr_b16 a[132:133], v22 offset:20992
  ds_read_b64_tr_b16 a[134:135], v23 offset:20992
  v_cvt_pk_bf16_f32 v226, v100, v101
  v_exp_f32 v104, v72
  v_add_f32 v56, v56, v102
  v_mfma_f32_32x32x16_bf16 v[208:223], a[140:143], v[228:231], v[208:223]
  ds_read_b64_tr_b16 a[140:141], v22 offset:23040
  ds_read_b64_tr_b16 a[142:143], v23 offset:23040
  v_exp_f32 v105, v73
  v_add_f32 v57, v57, v103
  v_cvt_pk_bf16_f32 v227, v102, v103
  s_waitcnt lgkmcnt(15)
  v_mfma_f32_32x32x16_bf16 v[80:95], a[48:51], a[0:3], v[112:127]
  v_exp_f32 v106, v74
  v_add_f32_e64 v56, v56, v104
  v_cvt_pk_bf16_f32 v228, v104, v105
  v_mfma_f32_32x32x16_bf16 v[80:95], a[52:55], a[4:7], v[80:95]
  v_add_u32 v63, s60, v17
  s_waitcnt vmcnt(8)
  ds_read_b128 a[144:147], v63 offset:0
  s_waitcnt lgkmcnt(1)
  buffer_load_dwordx4 v17, s[16:19], s36 offen offset:0 sc1 lds
  v_mfma_f32_32x32x16_bf16 v[80:95], a[56:59], a[8:11], v[80:95]
  ds_read_b128 a[148:151], v63 offset:1024
  v_exp_f32 v107, v75
  v_add_f32_e64 v57, v57, v105
  v_mfma_f32_32x32x16_bf16 v[80:95], a[60:63], a[12:15], v[80:95]
  ds_read_b128 a[152:155], v63 offset:2048
  s_cmp_eq_u32 s52, 4
  s_cbranch_scc0 L_nm4
  v_mov_b32 v77, 0xff800000
  v_mov_b32 v78, 0xff800000
  v_mov_b32 v79, 0xff800000
  v_mov_b32 v62, 0xff800000
  v_cndmask_b32 v76, v76, v62, s[44:45]
L_nm4:
  v_exp_f32 v108, v76
  v_add_f32 v56, v56, v106
  v_mfma_f32_32x32x16_bf16 v[80:95], a[64:67], a[16:19], v[80:95]
  ds_read_b128 a[156:159], v63 offset:3072
  buffer_load_dwordx4 v17, s[16:19], s36 offen offset:1024 sc1 lds
  v_cvt_pk_bf16_f32 v229, v106, v107
  v_mfma_f32_32x32x16_bf16 v[80:95], a[68:71], a[20:23], v[80:95]
  s_waitcnt vmcnt(6)
  ds_read_b128 a[160:163], v63 offset:4096
  v_exp_f32 v109, v77
  v_add_f32_e64 v57, v57, v107
  v_mfma_f32_32x32x16_bf16 v[80:95], a[72:75], a[24:27], v[80:95]
  ds_read_b128 a[164:167], v63 offset:5120
  buffer_load_dwordx4 v17, s[16:19], s36 offen offset:2048 sc1 lds
  v_exp_f32 v110, v78
  v_add_f32 v56, v56, v108
  v_mfma_f32_32x32x16_bf16 v[80:95], a[76:79], a[28:31], v[80:95]
  ds_read_b128 a[168:171], v63 offset:6144
  v_exp_f32 v111, v79
  v_add_f32 v57, v57, v109
  v_mfma_f32_32x32x16_bf16 v[80:95], a[80:83], a[32:35], v[80:95]
  ds_read_b128 a[172:175], v63 offset:7168
  buffer_load_dwordx4 v17, s[16:19], s36 offen offset:3072 sc1 lds
  s_add_u32 m0, s60, 16384
  s_add_u32 s36, s64, 12288
  v_cvt_pk_bf16_f32 v230, v108, v109
  v_add_f32_e64 v56, v56, v110
  v_mfma_f32_32x32x16_bf16 v[80:95], a[84:87], a[36:39], v[80:95]
  s_waitcnt vmcnt(4)
  ds_read_b128 a[176:179], v63 offset:8192
  v_add_f32 v57, v57, v111
  buffer_load_dwordx4 v18, s[16:19], s36 offen offset:0 sc1 lds
  v_mfma_f32_32x32x16_bf16 v[80:95], a[88:91], a[40:43], v[80:95]
  ds_read_b128 a[180:183], v63 offset:9216
  v_add_f32_e64 v56, v56, v57
  v_cvt_pk_bf16_f32 v231, v110, v111
  v_mfma_f32_32x32x16_bf16 v[80:95], a[92:95], a[44:47], v[80:95]
  ds_read_b128 a[184:187], v63 offset:10240
  ds_read_b128 a[188:191], v63 offset:11264
  buffer_load_dwordx4 v18, s[16:19], s36 offen offset:1024 sc1 lds
  v_cmp_nge_f32 vcc, s61, v56
  s_cbranch_vccnz L_rare_4
L_back_4:
  v_mfma_f32_32x32x16_bf16 v[128:143], a[96:99], v[224:227], v[128:143]
  ds_read_b64_tr_b16 a[96:97], v22 offset:24576
  ds_read_b64_tr_b16 a[98:99], v23 offset:24576
  v_add_f32_e64 v54, v54, v56
  buffer_load_dwordx4 v18, s[16:19], s36 offen offset:2048 sc1 lds
  v_mfma_f32_32x32x16_bf16 v[144:159], a[104:107], v[224:227], v[144:159]
  ds_read_b64_tr_b16 a[104:105], v22 offset:26624
  ds_read_b64_tr_b16 a[106:107], v23 offset:26624
  buffer_load_dwordx4 v18, s[16:19], s36 offen offset:3072 sc1 lds
  s_add_u32 m0, s60, 20480
  v_mfma_f32_32x32x16_bf16 v[160:175], a[112:115], v[224:227], v[160:175]
  ds_read_b64_tr_b16 a[112:113], v22 offset:28672
  ds_read_b64_tr_b16 a[114:115], v23 offset:28672
  s_cmp_eq_u32 s28, 3
  s_cbranch_scc0 L_ndum
  v_mov_b32 v80, 0xff800000
  v_mov_b32 v81, 0xff800000
  v_mov_b32 v82, 0xff800000
  v_mov_b32 v83, 0xff800000
  v_mov_b32 v84, 0xff800000
  v_mov_b32 v85, 0xff800000
  v_mov_b32 v86, 0xff800000
  v_mov_b32 v87, 0xff800000
  v_mov_b32 v88, 0xff800000
  v_mov_b32 v89, 0xff800000
  v_mov_b32 v90, 0xff800000
  v_mov_b32 v91, 0xff800000
  v_mov_b32 v92, 0xff800000
  v_mov_b32 v93, 0xff800000
  v_mov_b32 v94, 0xff800000
  v_mov_b32 v95, 0xff800000
L_ndum:
  v_mfma_f32_32x32x16_bf16 v[176:191], a[120:123], v[224:227], v[176:191]
  ds_read_b64_tr_b16 a[120:121], v22 offset:30720
  ds_read_b64_tr_b16 a[122:123], v23 offset:30720
  v_exp_f32_e64 v96, v80
  v_mfma_f32_32x32x16_bf16 v[192:207], a[128:131], v[224:227], v[192:207]
  ds_read_b64_tr_b16 a[128:129], v22 offset:32768
  ds_read_b64_tr_b16 a[130:131], v23 offset:32768
  v_exp_f32_e64 v97, v81
  buffer_load_dwordx4 v17, s[16:19], s65 offen offset:0 sc1 lds
  v_mfma_f32_32x32x16_bf16 v[208:223], a[136:139], v[224:227], v[208:223]
  ds_read_b64_tr_b16 a[136:137], v22 offset:34816
  ds_read_b64_tr_b16 a[138:139], v23 offset:34816
  v_exp_f32_e64 v98, v82
  v_mfma_f32_32x32x16_bf16 v[128:143], a[100:103], v[228:231], v[128:143]
  ds_read_b64_tr_b16 a[100:101], v22 offset:25088
  ds_read_b64_tr_b16 a[102:103], v23 offset:25088
  v_exp_f32 v99, v83
  v_add_f32 v56, v96, v97
  buffer_load_dwordx4 v17, s[16:19], s65 offen offset:1024 sc1 lds
  v_mfma_f32_32x32x16_bf16 v[144:159], a[108:111], v[228:231], v[144:159]
  ds_read_b64_tr_b16 a[108:109], v22 offset:27136
  ds_read_b64_tr_b16 a[110:111], v23 offset:27136
  v_exp_f32_e64 v100, v84
  v_cvt_pk_bf16_f32 v224, v96, v97
  v_mfma_f32_32x32x16_bf16 v[160:175], a[116:119], v[228:231], v[160:175]
  ds_read_b64_tr_b16 a[116:117], v22 offset:29184
  ds_read_b64_tr_b16 a[118:119], v23 offset:29184
  v_exp_f32 v101, v85
  v_add_f32 v57, v98, v99
  buffer_load_dwordx4 v17, s[16:19], s65 offen offset:2048 sc1 lds
  v_cvt_pk_bf16_f32 v225, v98, v99
  v_mfma_f32_32x32x16_bf16 v[176:191], a[124:127], v[228:231], v[176:191]
  ds_read_b64_tr_b16 a[124:125], v22 offset:31232
  ds_read_b64_tr_b16 a[126:127], v23 offset:31232
  v_exp_f32 v102, v86
  v_add_f32 v56, v56, v100
  buffer_load_dwordx4 v17, s[16:19], s65 offen offset:3072 sc1 lds
  v_mfma_f32_32x32x16_bf16 v[192:207], a[132:135], v[228:231], v[192:207]
  ds_read_b64_tr_b16 a[132:133], v22 offset:33280
  ds_read_b64_tr_b16 a[134:135], v23 offset:33280
  v_exp_f32 v103, v87
  v_add_f32 v57, v57, v101
  v_cvt_pk_bf16_f32 v226, v100, v101
  v_mfma_f32_32x32x16_bf16 v[208:223], a[140:143], v[228:231], v[208:223]
  ds_read_b64_tr_b16 a[140:141], v22 offset:35328
  ds_read_b64_tr_b16 a[142:143], v23 offset:35328
  v_exp_f32 v104, v88
  v_add_f32 v56, v56, v102
  v_exp_f32 v105, v89
  v_add_f32 v57, v57, v103
  v_cvt_pk_bf16_f32 v227, v102, v103
  s_cmp_eq_u32 s52, 5
  s_cbranch_scc0 L_nm5
  v_mov_b32 v93, 0xff800000
  v_mov_b32 v94, 0xff800000
  v_mov_b32 v95, 0xff800000
  v_mov_b32 v62, 0xff800000
  v_cndmask_b32 v92, v92, v62, s[44:45]
L_nm5:
  v_exp_f32 v106, v90
  v_add_f32 v56, v56, v104
  v_exp_f32 v107, v91
  v_add_f32 v57, v57, v105
  v_exp_f32 v108, v92
  v_add_f32 v56, v56, v106
  v_exp_f32 v109, v93
  v_add_f32 v57, v57, v107
  v_exp_f32 v110, v94
  v_add_f32 v56, v56, v108
  v_exp_f32 v111, v95
  v_add_f32 v57, v57, v109
  v_cvt_pk_bf16_f32 v228, v104, v105
  v_cvt_pk_bf16_f32 v229, v106, v107
  v_cvt_pk_bf16_f32 v230, v108, v109
  v_cvt_pk_bf16_f32 v231, v110, v111
  v_add_f32 v56, v56, v110
  v_add_f32 v57, v57, v111
  v_add_f32 v56, v56, v57
  v_cmp_nge_f32 vcc, s61, v56
  s_cbranch_vccnz L_rare_5
L_back_5:
  v_add_f32 v54, v54, v56
  v_mov_b32 v62, v54
  v_mov_b32_e64 v63, v54
  s_waitcnt lgkmcnt(15)
  v_mfma_f32_32x32x16_bf16 v[128:143], a[96:99], v[224:227], v[128:143]
  v_sub_f32 v88, 0, v112
  v_permlane32_swap_b32 v62, v63
  v_add_f32 v89, v62, v63
  s_waitcnt lgkmcnt(10)
  v_mfma_f32_32x32x16_bf16 v[128:143], a[100:103], v[228:231], v[128:143]
  ds_write_b64 v45, v[88:89]
  v_add_u32_e64 v62, s60, v17
  v_mfma_f32_32x32x16_bf16 v[144:159], a[104:107], v[224:227], v[144:159]
  s_waitcnt lgkmcnt(9)
  v_mfma_f32_32x32x16_bf16 v[144:159], a[108:111], v[228:231], v[144:159]
  s_waitcnt vmcnt(0)
  v_mfma_f32_32x32x16_bf16 v[160:175], a[112:115], v[224:227], v[160:175]
  ds_read_b128 a[192:195], v62 offset:12288
  ds_read_b128 a[196:199], v62 offset:13312
  s_waitcnt lgkmcnt(9)
  v_mfma_f32_32x32x16_bf16 v[160:175], a[116:119], v[228:231], v[160:175]
  ds_read_b128 a[200:203], v62 offset:14336
  ds_read_b128 a[204:207], v62 offset:15360
  v_mfma_f32_32x32x16_bf16 v[176:191], a[120:123], v[224:227], v[176:191]
  ds_read_b128 a[208:211], v62 offset:16384
  ds_read_b128 a[212:215], v62 offset:17408
  s_waitcnt lgkmcnt(11)
  v_mfma_f32_32x32x16_bf16 v[176:191], a[124:127], v[228:231], v[176:191]
  ds_read_b128 v[232:235], v26 offset:0
  ds_read_b128 v[236:239], v27 offset:1024
  v_mfma_f32_32x32x16_bf16 v[192:207], a[128:131], v[224:227], v[192:207]
  ds_read_b128 v[240:243], v26 offset:2048
  s_waitcnt lgkmcnt(12)
  v_mfma_f32_32x32x16_bf16 v[192:207], a[132:135], v[228:231], v[192:207]
  v_mfma_f32_32x32x16_bf16 v[208:223], a[136:139], v[224:227], v[208:223]
  s_waitcnt lgkmcnt(10)
  v_mfma_f32_32x32x16_bf16 v[208:223], a[140:143], v[228:231], v[208:223]
  s_waitcnt lgkmcnt(0)
  s_cmp_eq_u32 s28, 0
  s_cbranch_scc1 L_own0
  ds_write_b128 v47, v[128:131] offset:0
  ds_write_b128 v47, v[132:135] offset:1024
  ds_write_b128 v47, v[136:139] offset:2048
  ds_write_b128 v47, v[140:143] offset:3072
  ds_write_b128 v47, v[144:147] offset:4096
  ds_write_b128 v47, v[148:151] offset:5120
  s_branch L_nxt0
L_own0:
  v_mov_b32 v64, v128
  v_mov_b32 v65, v129
  v_mov_b32 v66, v130
  v_mov_b32 v67, v131
  v_mov_b32 v68, v132
  v_mov_b32 v69, v133
  v_mov_b32 v70, v134
  v_mov_b32 v71, v135
  v_mov_b32 v72, v136
  v_mov_b32 v73, v137
  v_mov_b32 v74, v138
  v_mov_b32 v75, v139
  v_mov_b32 v76, v140
  v_mov_b32 v77, v141
  v_mov_b32 v78, v142
  v_mov_b32 v79, v143
  v_mov_b32 v80, v144
  v_mov_b32 v81, v145
  v_mov_b32 v82, v146
  v_mov_b32 v83, v147
  v_mov_b32 v84, v148
  v_mov_b32 v85, v149
  v_mov_b32 v86, v150
  v_mov_b32 v87, v151
L_nxt0:
  v_permlane16_swap_b32 v232, v234
  v_permlane16_swap_b32 v233, v235
  v_permlane16_swap_b32 v236, v238
  v_permlane16_swap_b32 v237, v239
  v_permlane16_swap_b32 v240, v242
  v_permlane16_swap_b32 v241, v243
  v_lshlrev_b32_e64 v96, 16, v232
  v_and_b32 v97, 0xffff0000, v232
  v_lshlrev_b32_e64 v98, 16, v233
  v_and_b32 v99, 0xffff0000, v233
  v_lshlrev_b32_e64 v100, 16, v234
  v_and_b32 v101, 0xffff0000, v234
  v_lshlrev_b32_e64 v102, 16, v235
  v_and_b32 v103, 0xffff0000, v235
  s_cmp_eq_u32 s28, 1
  s_cbranch_scc1 L_own1
  ds_write_b128 v47, v[152:155] offset:6144
  ds_write_b128 v47, v[156:159] offset:7168
  ds_write_b128 v47, v[160:163] offset:8192
  ds_write_b128 v47, v[164:167] offset:9216
  ds_write_b128 v47, v[168:171] offset:10240
  ds_write_b128 v47, v[172:175] offset:11264
  s_branch L_nxt1
L_own1:
  v_mov_b32 v64, v152
  v_mov_b32 v65, v153
  v_mov_b32 v66, v154
  v_mov_b32 v67, v155
  v_mov_b32 v68, v156
  v_mov_b32 v69, v157
  v_mov_b32 v70, v158
  v_mov_b32 v71, v159
  v_mov_b32 v72, v160
  v_mov_b32 v73, v161
  v_mov_b32 v74, v162
  v_mov_b32 v75, v163
  v_mov_b32 v76, v164
  v_mov_b32 v77, v165
  v_mov_b32 v78, v166
  v_mov_b32 v79, v167
  v_mov_b32 v80, v168
  v_mov_b32 v81, v169
  v_mov_b32 v82, v170
  v_mov_b32 v83, v171
  v_mov_b32 v84, v172
  v_mov_b32 v85, v173
  v_mov_b32 v86, v174
  v_mov_b32 v87, v175
L_nxt1:
  v_lshlrev_b32 v104, 16, v236
  v_and_b32 v105, 0xffff0000, v236
  v_lshlrev_b32_e64 v106, 16, v237
  v_and_b32 v107, 0xffff0000, v237
  v_lshlrev_b32_e64 v108, 16, v238
  v_and_b32 v109, 0xffff0000, v238
  v_lshlrev_b32_e64 v110, 16, v239
  v_and_b32 v111, 0xffff0000, v239
  v_lshlrev_b32_e64 v112, 16, v240
  v_and_b32 v113, 0xffff0000, v240
  v_lshlrev_b32_e64 v114, 16, v241
  v_and_b32 v115, 0xffff0000, v241
  v_lshlrev_b32_e64 v116, 16, v242
  v_and_b32 v117, 0xffff0000, v242
  s_cmp_eq_u32 s28, 2
  s_cbranch_scc1 L_own2
  ds_write_b128 v47, v[176:179] offset:12288
  ds_write_b128 v47, v[180:183] offset:13312
  ds_write_b128 v47, v[184:187] offset:14336
  ds_write_b128 v47, v[188:191] offset:15360
  ds_write_b128 v47, v[192:195] offset:16384
  ds_write_b128 v47, v[196:199] offset:17408
  s_branch L_nxt2
L_own2:
  v_mov_b32 v64, v176
  v_mov_b32 v65, v177
  v_mov_b32 v66, v178
  v_mov_b32 v67, v179
  v_mov_b32 v68, v180
  v_mov_b32 v69, v181
  v_mov_b32 v70, v182
  v_mov_b32 v71, v183
  v_mov_b32 v72, v184
  v_mov_b32 v73, v185
  v_mov_b32 v74, v186
  v_mov_b32 v75, v187
  v_mov_b32 v76, v188
  v_mov_b32 v77, v189
  v_mov_b32 v78, v190
  v_mov_b32 v79, v191
  v_mov_b32 v80, v192
  v_mov_b32 v81, v193
  v_mov_b32 v82, v194
  v_mov_b32 v83, v195
  v_mov_b32 v84, v196
  v_mov_b32 v85, v197
  v_mov_b32 v86, v198
  v_mov_b32 v87, v199
L_nxt2:
  v_lshlrev_b32 v118, 16, v243
  v_and_b32 v119, 0xffff0000, v243
  v_fma_f32 v96, v96, v59, v58
  v_fma_f32 v97, v97, v59, v58
  v_fma_f32 v98, v98, v59, v58
  v_fma_f32 v99, v99, v59, v58
  v_fma_f32 v100, v100, v61, v60
  v_fma_f32 v101, v101, v61, v60
  v_fma_f32 v102, v102, v61, v60
  v_fma_f32 v103, v103, v61, v60
  v_fma_f32 v104, v104, v59, v58
  v_fma_f32 v105, v105, v59, v58
  v_fma_f32 v106, v106, v59, v58
  v_fma_f32 v107, v107, v59, v58
  s_cmp_eq_u32 s28, 3
  s_cbranch_scc1 L_own3
  s_nop 3
  ds_write_b128 v47, v[200:203] offset:18432
  ds_write_b128 v47, v[204:207] offset:19456
  ds_write_b128 v47, v[208:211] offset:20480
  ds_write_b128 v47, v[212:215] offset:21504
  ds_write_b128 v47, v[216:219] offset:22528
  ds_write_b128 v47, v[220:223] offset:23552
  s_branch L_nxt3
L_own3:
  s_nop 3
  v_mov_b32 v64, v200
  v_mov_b32 v65, v201
  v_mov_b32 v66, v202
  v_mov_b32 v67, v203
  v_mov_b32 v68, v204
  v_mov_b32 v69, v205
  v_mov_b32 v70, v206
  v_mov_b32 v71, v207
  v_mov_b32 v72, v208
  v_mov_b32 v73, v209
  v_mov_b32 v74, v210
  v_mov_b32 v75, v211
  v_mov_b32 v76, v212
  v_mov_b32 v77, v213
  v_mov_b32 v78, v214
  v_mov_b32 v79, v215
  v_mov_b32 v80, v216
  v_mov_b32 v81, v217
  v_mov_b32 v82, v218
  v_mov_b32 v83, v219
  v_mov_b32 v84, v220
  v_mov_b32 v85, v221
  v_mov_b32 v86, v222
  v_mov_b32_e64 v87, v223
L_nxt3:
  v_fma_f32 v108, v108, v61, v60
  v_fma_f32 v109, v109, v61, v60
  v_fma_f32 v110, v110, v61, v60
  v_fma_f32 v111, v111, v61, v60
  v_fma_f32 v112, v112, v59, v58
  v_fma_f32 v113, v113, v59, v58
  v_fma_f32 v114, v114, v59, v58
  v_fma_f32 v115, v115, v59, v58
  v_fma_f32 v116, v116, v61, v60
  v_fma_f32 v117, v117, v61, v60
  v_fma_f32 v118, v118, v61, v60
  v_fma_f32 v119, v119, v61, v60
  s_waitcnt lgkmcnt(0)
  s_barrier
  ds_read_b64 v[90:91], v51
  ds_read_b64 v[92:93], v52
  ds_read_b64 v[94:95], v53
  ds_read_b128 v[128:131], v48 offset:0
  ds_read_b128 v[132:135], v48 offset:1024
  ds_read_b128 v[136:139], v48 offset:2048
  ds_read_b128 v[140:143], v48 offset:3072
  ds_read_b128 v[144:147], v48 offset:4096
  ds_read_b128 v[148:151], v48 offset:5120
  ds_read_b128 v[152:155], v49 offset:0
  ds_read_b128 v[156:159], v49 offset:1024
  ds_read_b128 v[160:163], v49 offset:2048
  ds_read_b128 v[164:167], v49 offset:3072
  ds_read_b128 v[168:171], v49 offset:4096
  ds_read_b128 v[172:175], v49 offset:5120
  ds_read_b128 v[176:179], v50 offset:0
  ds_read_b128 v[180:183], v50 offset:1024
  ds_read_b128 v[184:187], v50 offset:2048
  ds_read_b128 v[188:191], v50 offset:3072
  ds_read_b128 v[192:195], v50 offset:4096
  ds_read_b128 v[196:199], v50 offset:5120
  s_waitcnt lgkmcnt(15)
  v_max3_f32 v55, v88, v90, v92
  v_max_f32 v55, v55, v94
  v_sub_f32 v88, v88, v55
  v_sub_f32 v90, v90, v55
  v_sub_f32 v92, v92, v55
  v_sub_f32 v94, v94, v55
  v_exp_f32 v88, v88
  v_exp_f32 v90, v90
  v_exp_f32 v92, v92
  v_exp_f32 v94, v94
  s_nop 0
  v_mul_f32 v55, v88, v89
  v_fmac_f32 v55, v90, v91
  v_fmac_f32 v55, v92, v93
  v_fmac_f32 v55, v94, v95
  v_rcp_f32 v55, v55
  s_nop 0
  v_mul_f32 v88, v88, v55
  v_mul_f32 v90, v90, v55
  v_mul_f32 v92, v92, v55
  v_mul_f32 v94, v94, v55
  v_mov_b32 v89, v88
  v_mov_b32 v91, v90
  v_mov_b32 v93, v92
  v_mov_b32_e64 v95, v94
  v_pk_mul_f32 v[64:65], v[64:65], v[88:89]
  v_pk_mul_f32 v[66:67], v[66:67], v[88:89]
  v_pk_mul_f32 v[68:69], v[68:69], v[88:89]
  v_pk_mul_f32 v[70:71], v[70:71], v[88:89]
  v_pk_mul_f32 v[72:73], v[72:73], v[88:89]
  v_pk_mul_f32 v[74:75], v[74:75], v[88:89]
  v_pk_mul_f32 v[76:77], v[76:77], v[88:89]
  v_pk_mul_f32 v[78:79], v[78:79], v[88:89]
  v_pk_mul_f32 v[80:81], v[80:81], v[88:89]
  v_pk_mul_f32 v[82:83], v[82:83], v[88:89]
  v_pk_mul_f32 v[84:85], v[84:85], v[88:89]
  v_pk_mul_f32 v[86:87], v[86:87], v[88:89]
  s_waitcnt lgkmcnt(12)
  v_pk_fma_f32 v[64:65], v[128:129], v[90:91], v[64:65]
  v_pk_fma_f32 v[66:67], v[130:131], v[90:91], v[66:67]
  v_pk_fma_f32 v[68:69], v[132:133], v[90:91], v[68:69]
  v_pk_fma_f32 v[70:71], v[134:135], v[90:91], v[70:71]
  v_pk_fma_f32 v[72:73], v[136:137], v[90:91], v[72:73]
  v_pk_fma_f32 v[74:75], v[138:139], v[90:91], v[74:75]
  v_pk_fma_f32 v[76:77], v[140:141], v[90:91], v[76:77]
  v_pk_fma_f32 v[78:79], v[142:143], v[90:91], v[78:79]
  v_pk_fma_f32 v[80:81], v[144:145], v[90:91], v[80:81]
  v_pk_fma_f32 v[82:83], v[146:147], v[90:91], v[82:83]
  v_pk_fma_f32 v[84:85], v[148:149], v[90:91], v[84:85]
  v_pk_fma_f32 v[86:87], v[150:151], v[90:91], v[86:87]
  s_waitcnt lgkmcnt(6)
  v_pk_fma_f32 v[64:65], v[152:153], v[92:93], v[64:65]
  v_pk_fma_f32 v[66:67], v[154:155], v[92:93], v[66:67]
  v_pk_fma_f32 v[68:69], v[156:157], v[92:93], v[68:69]
  v_pk_fma_f32 v[70:71], v[158:159], v[92:93], v[70:71]
  v_pk_fma_f32 v[72:73], v[160:161], v[92:93], v[72:73]
  v_pk_fma_f32 v[74:75], v[162:163], v[92:93], v[74:75]
  v_pk_fma_f32 v[76:77], v[164:165], v[92:93], v[76:77]
  v_pk_fma_f32 v[78:79], v[166:167], v[92:93], v[78:79]
  v_pk_fma_f32 v[80:81], v[168:169], v[92:93], v[80:81]
  v_pk_fma_f32 v[82:83], v[170:171], v[92:93], v[82:83]
  v_pk_fma_f32 v[84:85], v[172:173], v[92:93], v[84:85]
  v_pk_fma_f32 v[86:87], v[174:175], v[92:93], v[86:87]
  s_waitcnt lgkmcnt(0)
  v_pk_fma_f32 v[64:65], v[176:177], v[94:95], v[64:65]
  v_pk_fma_f32 v[66:67], v[178:179], v[94:95], v[66:67]
  v_cvt_pk_bf16_f32 v120, v64, v65
  v_cvt_pk_bf16_f32 v121, v66, v67
  ds_write_b64 v39, v[120:121] offset:0
  v_pk_fma_f32 v[68:69], v[180:181], v[94:95], v[68:69]
  v_pk_fma_f32 v[70:71], v[182:183], v[94:95], v[70:71]
  v_cvt_pk_bf16_f32 v122, v68, v69
  v_cvt_pk_bf16_f32 v123, v70, v71
  ds_write_b64 v40, v[122:123] offset:512
  v_pk_fma_f32 v[72:73], v[184:185], v[94:95], v[72:73]
  v_pk_fma_f32 v[74:75], v[186:187], v[94:95], v[74:75]
  v_cvt_pk_bf16_f32 v124, v72, v73
  v_cvt_pk_bf16_f32 v125, v74, v75
  ds_write_b64 v41, v[124:125] offset:1024
  v_pk_fma_f32 v[76:77], v[188:189], v[94:95], v[76:77]
  v_pk_fma_f32 v[78:79], v[190:191], v[94:95], v[78:79]
  v_cvt_pk_bf16_f32 v126, v76, v77
  v_cvt_pk_bf16_f32 v127, v78, v79
  ds_write_b64 v42, v[126:127] offset:1536
  v_pk_fma_f32 v[80:81], v[192:193], v[94:95], v[80:81]
  v_pk_fma_f32 v[82:83], v[194:195], v[94:95], v[82:83]
  v_cvt_pk_bf16_f32 v120, v80, v81
  v_cvt_pk_bf16_f32 v121, v82, v83
  ds_write_b64 v43, v[120:121] offset:2048
  v_pk_fma_f32 v[84:85], v[196:197], v[94:95], v[84:85]
  v_pk_fma_f32 v[86:87], v[198:199], v[94:95], v[86:87]
  v_cvt_pk_bf16_f32 v122, v84, v85
  v_cvt_pk_bf16_f32 v123, v86, v87
  ds_write_b64 v44, v[122:123] offset:2560
  s_waitcnt lgkmcnt(0)
  s_barrier
  ds_read_b128 a[0:3], v28 offset:0
  ds_read_b128 a[24:27], v28 offset:256
  ds_read_b128 a[4:7], v29 offset:2048
  ds_read_b128 a[28:31], v29 offset:2304
  ds_read_b128 a[8:11], v28 offset:4096
  ds_read_b128 a[32:35], v28 offset:4352
  ds_read_b128 a[12:15], v29 offset:6144
  ds_read_b128 a[36:39], v29 offset:6400
  ds_read_b128 a[16:19], v28 offset:8192
  ds_read_b128 a[40:43], v28 offset:8448
  ds_read_b128 a[20:23], v29 offset:10240
  ds_read_b128 a[44:47], v29 offset:10496
  s_waitcnt lgkmcnt(10)
  v_mfma_f32_16x16x32_bf16 v[96:99], a[144:147], a[0:3], v[96:99]
  v_mfma_f32_16x16x32_bf16 v[100:103], a[144:147], a[24:27], v[100:103]
  v_mfma_f32_16x16x32_bf16 v[104:107], a[168:171], a[0:3], v[104:107]
  v_mfma_f32_16x16x32_bf16 v[108:111], a[168:171], a[24:27], v[108:111]
  v_mfma_f32_16x16x32_bf16 v[112:115], a[192:195], a[0:3], v[112:115]
  v_mfma_f32_16x16x32_bf16 v[116:119], a[192:195], a[24:27], v[116:119]
  s_waitcnt lgkmcnt(8)
  v_mfma_f32_16x16x32_bf16 v[96:99], a[148:151], a[4:7], v[96:99]
  v_mfma_f32_16x16x32_bf16 v[100:103], a[148:151], a[28:31], v[100:103]
  v_mfma_f32_16x16x32_bf16 v[104:107], a[172:175], a[4:7], v[104:107]
  v_mfma_f32_16x16x32_bf16 v[108:111], a[172:175], a[28:31], v[108:111]
  v_mfma_f32_16x16x32_bf16 v[112:115], a[196:199], a[4:7], v[112:115]
  v_mfma_f32_16x16x32_bf16 v[116:119], a[196:199], a[28:31], v[116:119]
  s_waitcnt lgkmcnt(6)
  v_mfma_f32_16x16x32_bf16 v[96:99], a[152:155], a[8:11], v[96:99]
  v_mfma_f32_16x16x32_bf16 v[100:103], a[152:155], a[32:35], v[100:103]
  v_mfma_f32_16x16x32_bf16 v[104:107], a[176:179], a[8:11], v[104:107]
  v_mfma_f32_16x16x32_bf16 v[108:111], a[176:179], a[32:35], v[108:111]
  v_mfma_f32_16x16x32_bf16 v[112:115], a[200:203], a[8:11], v[112:115]
  v_mfma_f32_16x16x32_bf16 v[116:119], a[200:203], a[32:35], v[116:119]
  s_waitcnt lgkmcnt(4)
  v_mfma_f32_16x16x32_bf16 v[96:99], a[156:159], a[12:15], v[96:99]
  v_mfma_f32_16x16x32_bf16 v[100:103], a[156:159], a[36:39], v[100:103]
  v_mfma_f32_16x16x32_bf16 v[104:107], a[180:183], a[12:15], v[104:107]
  v_mfma_f32_16x16x32_bf16 v[108:111], a[180:183], a[36:39], v[108:111]
  v_mfma_f32_16x16x32_bf16 v[112:115], a[204:207], a[12:15], v[112:115]
  v_mfma_f32_16x16x32_bf16 v[116:119], a[204:207], a[36:39], v[116:119]
  s_waitcnt lgkmcnt(2)
  v_mfma_f32_16x16x32_bf16 v[96:99], a[160:163], a[16:19], v[96:99]
  v_mfma_f32_16x16x32_bf16 v[100:103], a[160:163], a[40:43], v[100:103]
  v_mfma_f32_16x16x32_bf16 v[104:107], a[184:187], a[16:19], v[104:107]
  v_mfma_f32_16x16x32_bf16 v[108:111], a[184:187], a[40:43], v[108:111]
  v_mfma_f32_16x16x32_bf16 v[112:115], a[208:211], a[16:19], v[112:115]
  v_mfma_f32_16x16x32_bf16 v[116:119], a[208:211], a[40:43], v[116:119]
  s_waitcnt lgkmcnt(0)
  v_mfma_f32_16x16x32_bf16 v[96:99], a[164:167], a[20:23], v[96:99]
  v_mfma_f32_16x16x32_bf16 v[100:103], a[164:167], a[44:47], v[100:103]
  v_mfma_f32_16x16x32_bf16 v[104:107], a[188:191], a[20:23], v[104:107]
  v_mfma_f32_16x16x32_bf16 v[108:111], a[188:191], a[44:47], v[108:111]
  v_mfma_f32_16x16x32_bf16 v[112:115], a[212:215], a[20:23], v[112:115]
  v_mfma_f32_16x16x32_bf16 v[116:119], a[212:215], a[44:47], v[116:119]
  s_nop 2
  v_cvt_pk_bf16_f32 v64, v96, v97
  v_cvt_pk_bf16_f32 v65, v98, v99
  v_cvt_pk_bf16_f32 v66, v100, v101
  v_cvt_pk_bf16_f32 v67, v102, v103
  v_cvt_pk_bf16_f32 v68, v104, v105
  v_cvt_pk_bf16_f32 v69, v106, v107
  v_cvt_pk_bf16_f32 v70, v108, v109
  v_cvt_pk_bf16_f32 v71, v110, v111
  v_permlane16_swap_b32 v64, v66
  v_permlane16_swap_b32 v65, v67
  buffer_store_dwordx4 v[64:67], v33, s[20:23], 0 offen offset:0
  v_cvt_pk_bf16_f32 v72, v112, v113
  v_cvt_pk_bf16_f32 v73, v114, v115
  v_cvt_pk_bf16_f32 v74, v116, v117
  v_cvt_pk_bf16_f32 v75, v118, v119
  v_permlane16_swap_b32 v68, v70
  v_permlane16_swap_b32 v69, v71
  buffer_store_dwordx4 v[68:71], v33, s[20:23], 0 offen offset:32
  s_nop 0
  v_permlane16_swap_b32 v72, v74
  v_permlane16_swap_b32_e64 v73, v75
  buffer_store_dwordx4 v[72:75], v33, s[20:23], 0 offen offset:64
  s_branch L_end
L_rare_0:
  s_mov_b32 s67, 0
  s_branch L_rare_p0
L_rare_1:
  s_mov_b32 s67, 1
  s_branch L_rare_p1
L_rare_2:
  s_mov_b32 s67, 2
  s_branch L_rare_p0
L_rare_3:
  s_mov_b32 s67, 3
  s_branch L_rare_p1
L_rare_4:
  s_mov_b32 s67, 4
  s_branch L_rare_p0
L_rare_5:
  s_mov_b32 s67, 5
  s_branch L_rare_p1
L_rare_p0:
  s_nop 11
  v_max3_f32 v55, v64, v65, v66
  v_max3_f32 v55, v55, v67, v68
  v_max3_f32 v55, v55, v69, v70
  v_max3_f32 v55, v55, v71, v72
  v_max3_f32 v55, v55, v73, v74
  v_max3_f32 v55, v55, v75, v76
  v_max3_f32 v55, v55, v77, v78
  v_max_f32 v55, v55, v79
  v_mov_b32 v62, v55
  v_mov_b32 v63, v54
  v_mov_b32 v46, v54
  s_nop 0
  v_permlane32_swap_b32 v55, v62
  v_permlane32_swap_b32 v63, v46
  v_max_f32 v55, v55, v62
  v_add_f32 v63, v63, v46
  v_max_f32 v62, 0, v55
  v_cmp_eq_f32 vcc, 0, v63
  s_nop 1
  v_cndmask_b32 v55, v62, v55, vcc
  v_sub_f32 v62, 0, v55
  v_exp_f32 v62, v62
  s_nop 0
  v_cndmask_b32 v62, v62, 1.0, vcc
  s_cmp_eq_u32 s67, 0
  s_cbranch_scc1 L_rare_noO0
  v_mul_f32 v128, v128, v62
  v_mul_f32 v129, v129, v62
  v_mul_f32 v130, v130, v62
  v_mul_f32 v131, v131, v62
  v_mul_f32 v132, v132, v62
  v_mul_f32 v133, v133, v62
  v_mul_f32 v134, v134, v62
  v_mul_f32 v135, v135, v62
  v_mul_f32 v136, v136, v62
  v_mul_f32 v137, v137, v62
  v_mul_f32 v138, v138, v62
  v_mul_f32 v139, v139, v62
  v_mul_f32 v140, v140, v62
  v_mul_f32 v141, v141, v62
  v_mul_f32 v142, v142, v62
  v_mul_f32 v143, v143, v62
  v_mul_f32 v144, v144, v62
  v_mul_f32 v145, v145, v62
  v_mul_f32 v146, v146, v62
  v_mul_f32 v147, v147, v62
  v_mul_f32 v148, v148, v62
  v_mul_f32 v149, v149, v62
  v_mul_f32 v150, v150, v62
  v_mul_f32 v151, v151, v62
  v_mul_f32 v152, v152, v62
  v_mul_f32 v153, v153, v62
  v_mul_f32 v154, v154, v62
  v_mul_f32 v155, v155, v62
  v_mul_f32 v156, v156, v62
  v_mul_f32 v157, v157, v62
  v_mul_f32 v158, v158, v62
  v_mul_f32 v159, v159, v62
  v_mul_f32 v160, v160, v62
  v_mul_f32 v161, v161, v62
  v_mul_f32 v162, v162, v62
  v_mul_f32 v163, v163, v62
  v_mul_f32 v164, v164, v62
  v_mul_f32 v165, v165, v62
  v_mul_f32 v166, v166, v62
  v_mul_f32 v167, v167, v62
  v_mul_f32 v168, v168, v62
  v_mul_f32 v169, v169, v62
  v_mul_f32 v170, v170, v62
  v_mul_f32 v171, v171, v62
  v_mul_f32 v172, v172, v62
  v_mul_f32 v173, v173, v62
  v_mul_f32 v174, v174, v62
  v_mul_f32 v175, v175, v62
  v_mul_f32 v176, v176, v62
  v_mul_f32 v177, v177, v62
  v_mul_f32 v178, v178, v62
  v_mul_f32 v179, v179, v62
  v_mul_f32 v180, v180, v62
  v_mul_f32 v181, v181, v62
  v_mul_f32 v182, v182, v62
  v_mul_f32 v183, v183, v62
  v_mul_f32 v184, v184, v62
  v_mul_f32 v185, v185, v62
  v_mul_f32 v186, v186, v62
  v_mul_f32 v187, v187, v62
  v_mul_f32 v188, v188, v62
  v_mul_f32 v189, v189, v62
  v_mul_f32 v190, v190, v62
  v_mul_f32 v191, v191, v62
  v_mul_f32 v192, v192, v62
  v_mul_f32 v193, v193, v62
  v_mul_f32 v194, v194, v62
  v_mul_f32 v195, v195, v62
  v_mul_f32 v196, v196, v62
  v_mul_f32 v197, v197, v62
  v_mul_f32 v198, v198, v62
  v_mul_f32 v199, v199, v62
  v_mul_f32 v200, v200, v62
  v_mul_f32 v201, v201, v62
  v_mul_f32 v202, v202, v62
  v_mul_f32 v203, v203, v62
  v_mul_f32 v204, v204, v62
  v_mul_f32 v205, v205, v62
  v_mul_f32 v206, v206, v62
  v_mul_f32 v207, v207, v62
  v_mul_f32 v208, v208, v62
  v_mul_f32 v209, v209, v62
  v_mul_f32 v210, v210, v62
  v_mul_f32 v211, v211, v62
  v_mul_f32 v212, v212, v62
  v_mul_f32 v213, v213, v62
  v_mul_f32 v214, v214, v62
  v_mul_f32 v215, v215, v62
  v_mul_f32 v216, v216, v62
  v_mul_f32 v217, v217, v62
  v_mul_f32 v218, v218, v62
  v_mul_f32 v219, v219, v62
  v_mul_f32 v220, v220, v62
  v_mul_f32 v221, v221, v62
  v_mul_f32 v222, v222, v62
  v_mul_f32 v223, v223, v62
L_rare_noO0:
  v_mul_f32 v54, v54, v62
  v_sub_f32 v112, v112, v55
  v_sub_f32 v113, v113, v55
  v_sub_f32 v114, v114, v55
  v_sub_f32 v115, v115, v55
  v_sub_f32 v116, v116, v55
  v_sub_f32 v117, v117, v55
  v_sub_f32 v118, v118, v55
  v_sub_f32 v119, v119, v55
  v_sub_f32 v120, v120, v55
  v_sub_f32 v121, v121, v55
  v_sub_f32 v122, v122, v55
  v_sub_f32 v123, v123, v55
  v_sub_f32 v124, v124, v55
  v_sub_f32 v125, v125, v55
  v_sub_f32 v126, v126, v55
  v_sub_f32 v127, v127, v55
  v_sub_f32 v64, v64, v55
  v_sub_f32 v65, v65, v55
  v_sub_f32 v66, v66, v55
  v_sub_f32 v67, v67, v55
  v_sub_f32 v68, v68, v55
  v_sub_f32 v69, v69, v55
  v_sub_f32 v70, v70, v55
  v_sub_f32 v71, v71, v55
  v_sub_f32 v72, v72, v55
  v_sub_f32 v73, v73, v55
  v_sub_f32 v74, v74, v55
  v_sub_f32 v75, v75, v55
  v_sub_f32 v76, v76, v55
  v_sub_f32 v77, v77, v55
  v_sub_f32 v78, v78, v55
  v_sub_f32 v79, v79, v55
  s_cmp_eq_u32 s67, 5
  s_cbranch_scc1 L_rare_noN0
  v_sub_f32 v80, v80, v55
  v_sub_f32 v81, v81, v55
  v_sub_f32 v82, v82, v55
  v_sub_f32 v83, v83, v55
  v_sub_f32 v84, v84, v55
  v_sub_f32 v85, v85, v55
  v_sub_f32 v86, v86, v55
  v_sub_f32 v87, v87, v55
  v_sub_f32 v88, v88, v55
  v_sub_f32 v89, v89, v55
  v_sub_f32 v90, v90, v55
  v_sub_f32 v91, v91, v55
  v_sub_f32 v92, v92, v55
  v_sub_f32 v93, v93, v55
  v_sub_f32 v94, v94, v55
  v_sub_f32 v95, v95, v55
L_rare_noN0:
  v_exp_f32 v96, v64
  v_exp_f32 v97, v65
  v_exp_f32 v98, v66
  v_exp_f32 v99, v67
  v_exp_f32 v100, v68
  v_exp_f32 v101, v69
  v_exp_f32 v102, v70
  v_exp_f32 v103, v71
  v_exp_f32 v104, v72
  v_exp_f32 v105, v73
  v_exp_f32 v106, v74
  v_exp_f32 v107, v75
  v_exp_f32 v108, v76
  v_exp_f32 v109, v77
  v_exp_f32 v110, v78
  v_exp_f32 v111, v79
  s_nop 0
  v_add_f32 v56, v96, v97
  v_add_f32 v56, v56, v98
  v_add_f32 v56, v56, v99
  v_add_f32 v56, v56, v100
  v_add_f32 v56, v56, v101
  v_add_f32 v56, v56, v102
  v_add_f32 v56, v56, v103
  v_add_f32 v56, v56, v104
  v_add_f32 v56, v56, v105
  v_add_f32 v56, v56, v106
  v_add_f32 v56, v56, v107
  v_add_f32 v56, v56, v108
  v_add_f32 v56, v56, v109
  v_add_f32 v56, v56, v110
  v_add_f32_e64 v56, v56, v111
  v_cvt_pk_bf16_f32 v224, v96, v97
  v_cvt_pk_bf16_f32 v225, v98, v99
  v_cvt_pk_bf16_f32 v226, v100, v101
  v_cvt_pk_bf16_f32 v227, v102, v103
  v_cvt_pk_bf16_f32 v228, v104, v105
  v_cvt_pk_bf16_f32 v229, v106, v107
  v_cvt_pk_bf16_f32 v230, v108, v109
  v_cvt_pk_bf16_f32 v231, v110, v111
  s_cmp_eq_u32 s67, 0
  s_cbranch_scc1 L_back_0
  s_cmp_eq_u32 s67, 2
  s_cbranch_scc1 L_back_2
  s_cmp_eq_u32 s67, 4
  s_cbranch_scc1 L_back_4
  s_branch L_end
L_rare_p1:
  s_nop 11
  v_max3_f32 v55, v80, v81, v82
  v_max3_f32 v55, v55, v83, v84
  v_max3_f32 v55, v55, v85, v86
  v_max3_f32 v55, v55, v87, v88
  v_max3_f32 v55, v55, v89, v90
  v_max3_f32 v55, v55, v91, v92
  v_max3_f32 v55, v55, v93, v94
  v_max_f32 v55, v55, v95
  v_mov_b32 v62, v55
  v_mov_b32 v63, v54
  v_mov_b32 v46, v54
  s_nop 0
  v_permlane32_swap_b32 v55, v62
  v_permlane32_swap_b32 v63, v46
  v_max_f32 v55, v55, v62
  v_add_f32 v63, v63, v46
  v_max_f32 v62, 0, v55
  v_cmp_eq_f32 vcc, 0, v63
  s_nop 1
  v_cndmask_b32 v55, v62, v55, vcc
  v_sub_f32 v62, 0, v55
  v_exp_f32 v62, v62
  s_nop 0
  v_cndmask_b32 v62, v62, 1.0, vcc
  s_cmp_eq_u32 s67, 0
  s_cbranch_scc1 L_rare_noO1
  v_mul_f32 v128, v128, v62
  v_mul_f32 v129, v129, v62
  v_mul_f32 v130, v130, v62
  v_mul_f32 v131, v131, v62
  v_mul_f32 v132, v132, v62
  v_mul_f32 v133, v133, v62
  v_mul_f32 v134, v134, v62
  v_mul_f32 v135, v135, v62
  v_mul_f32 v136, v136, v62
  v_mul_f32 v137, v137, v62
  v_mul_f32 v138, v138, v62
  v_mul_f32 v139, v139, v62
  v_mul_f32 v140, v140, v62
  v_mul_f32 v141, v141, v62
  v_mul_f32 v142, v142, v62
  v_mul_f32 v143, v143, v62
  v_mul_f32 v144, v144, v62
  v_mul_f32 v145, v145, v62
  v_mul_f32 v146, v146, v62
  v_mul_f32 v147, v147, v62
  v_mul_f32 v148, v148, v62
  v_mul_f32 v149, v149, v62
  v_mul_f32 v150, v150, v62
  v_mul_f32 v151, v151, v62
  v_mul_f32 v152, v152, v62
  v_mul_f32 v153, v153, v62
  v_mul_f32 v154, v154, v62
  v_mul_f32 v155, v155, v62
  v_mul_f32 v156, v156, v62
  v_mul_f32 v157, v157, v62
  v_mul_f32 v158, v158, v62
  v_mul_f32 v159, v159, v62
  v_mul_f32 v160, v160, v62
  v_mul_f32 v161, v161, v62
  v_mul_f32 v162, v162, v62
  v_mul_f32 v163, v163, v62
  v_mul_f32 v164, v164, v62
  v_mul_f32 v165, v165, v62
  v_mul_f32 v166, v166, v62
  v_mul_f32 v167, v167, v62
  v_mul_f32 v168, v168, v62
  v_mul_f32 v169, v169, v62
  v_mul_f32 v170, v170, v62
  v_mul_f32 v171, v171, v62
  v_mul_f32 v172, v172, v62
  v_mul_f32 v173, v173, v62
  v_mul_f32 v174, v174, v62
  v_mul_f32 v175, v175, v62
  v_mul_f32 v176, v176, v62
  v_mul_f32 v177, v177, v62
  v_mul_f32 v178, v178, v62
  v_mul_f32 v179, v179, v62
  v_mul_f32 v180, v180, v62
  v_mul_f32 v181, v181, v62
  v_mul_f32 v182, v182, v62
  v_mul_f32 v183, v183, v62
  v_mul_f32 v184, v184, v62
  v_mul_f32 v185, v185, v62
  v_mul_f32 v186, v186, v62
  v_mul_f32 v187, v187, v62
  v_mul_f32 v188, v188, v62
  v_mul_f32 v189, v189, v62
  v_mul_f32 v190, v190, v62
  v_mul_f32 v191, v191, v62
  v_mul_f32 v192, v192, v62
  v_mul_f32 v193, v193, v62
  v_mul_f32 v194, v194, v62
  v_mul_f32 v195, v195, v62
  v_mul_f32 v196, v196, v62
  v_mul_f32 v197, v197, v62
  v_mul_f32 v198, v198, v62
  v_mul_f32 v199, v199, v62
  v_mul_f32 v200, v200, v62
  v_mul_f32 v201, v201, v62
  v_mul_f32 v202, v202, v62
  v_mul_f32 v203, v203, v62
  v_mul_f32 v204, v204, v62
  v_mul_f32 v205, v205, v62
  v_mul_f32 v206, v206, v62
  v_mul_f32 v207, v207, v62
  v_mul_f32 v208, v208, v62
  v_mul_f32 v209, v209, v62
  v_mul_f32 v210, v210, v62
  v_mul_f32 v211, v211, v62
  v_mul_f32 v212, v212, v62
  v_mul_f32 v213, v213, v62
  v_mul_f32 v214, v214, v62
  v_mul_f32 v215, v215, v62
  v_mul_f32 v216, v216, v62
  v_mul_f32 v217, v217, v62
  v_mul_f32 v218, v218, v62
  v_mul_f32 v219, v219, v62
  v_mul_f32 v220, v220, v62
  v_mul_f32 v221, v221, v62
  v_mul_f32 v222, v222, v62
  v_mul_f32 v223, v223, v62
L_rare_noO1:
  v_mul_f32 v54, v54, v62
  v_sub_f32 v112, v112, v55
  v_sub_f32 v113, v113, v55
  v_sub_f32 v114, v114, v55
  v_sub_f32 v115, v115, v55
  v_sub_f32 v116, v116, v55
  v_sub_f32 v117, v117, v55
  v_sub_f32 v118, v118, v55
  v_sub_f32 v119, v119, v55
  v_sub_f32 v120, v120, v55
  v_sub_f32 v121, v121, v55
  v_sub_f32 v122, v122, v55
  v_sub_f32 v123, v123, v55
  v_sub_f32 v124, v124, v55
  v_sub_f32 v125, v125, v55
  v_sub_f32 v126, v126, v55
  v_sub_f32 v127, v127, v55
  v_sub_f32 v80, v80, v55
  v_sub_f32 v81, v81, v55
  v_sub_f32 v82, v82, v55
  v_sub_f32 v83, v83, v55
  v_sub_f32 v84, v84, v55
  v_sub_f32 v85, v85, v55
  v_sub_f32 v86, v86, v55
  v_sub_f32 v87, v87, v55
  v_sub_f32 v88, v88, v55
  v_sub_f32 v89, v89, v55
  v_sub_f32 v90, v90, v55
  v_sub_f32 v91, v91, v55
  v_sub_f32 v92, v92, v55
  v_sub_f32 v93, v93, v55
  v_sub_f32 v94, v94, v55
  v_sub_f32 v95, v95, v55
  s_cmp_eq_u32 s67, 5
  s_cbranch_scc1 L_rare_noN1
  v_sub_f32 v64, v64, v55
  v_sub_f32 v65, v65, v55
  v_sub_f32 v66, v66, v55
  v_sub_f32 v67, v67, v55
  v_sub_f32 v68, v68, v55
  v_sub_f32 v69, v69, v55
  v_sub_f32 v70, v70, v55
  v_sub_f32 v71, v71, v55
  v_sub_f32 v72, v72, v55
  v_sub_f32 v73, v73, v55
  v_sub_f32 v74, v74, v55
  v_sub_f32 v75, v75, v55
  v_sub_f32 v76, v76, v55
  v_sub_f32 v77, v77, v55
  v_sub_f32 v78, v78, v55
  v_sub_f32 v79, v79, v55
L_rare_noN1:
  v_exp_f32 v96, v80
  v_exp_f32 v97, v81
  v_exp_f32 v98, v82
  v_exp_f32 v99, v83
  v_exp_f32 v100, v84
  v_exp_f32 v101, v85
  v_exp_f32 v102, v86
  v_exp_f32 v103, v87
  v_exp_f32 v104, v88
  v_exp_f32 v105, v89
  v_exp_f32 v106, v90
  v_exp_f32 v107, v91
  v_exp_f32 v108, v92
  v_exp_f32 v109, v93
  v_exp_f32 v110, v94
  v_exp_f32 v111, v95
  s_nop 0
  v_add_f32 v56, v96, v97
  v_add_f32 v56, v56, v98
  v_add_f32 v56, v56, v99
  v_add_f32 v56, v56, v100
  v_add_f32 v56, v56, v101
  v_add_f32 v56, v56, v102
  v_add_f32 v56, v56, v103
  v_add_f32 v56, v56, v104
  v_add_f32 v56, v56, v105
  v_add_f32 v56, v56, v106
  v_add_f32 v56, v56, v107
  v_add_f32 v56, v56, v108
  v_add_f32 v56, v56, v109
  v_add_f32 v56, v56, v110
  v_add_f32_e64 v56, v56, v111
  v_cvt_pk_bf16_f32 v224, v96, v97
  v_cvt_pk_bf16_f32 v225, v98, v99
  v_cvt_pk_bf16_f32 v226, v100, v101
  v_cvt_pk_bf16_f32 v227, v102, v103
  v_cvt_pk_bf16_f32 v228, v104, v105
  v_cvt_pk_bf16_f32 v229, v106, v107
  v_cvt_pk_bf16_f32 v230, v108, v109
  v_cvt_pk_bf16_f32 v231, v110, v111
  s_cmp_eq_u32 s67, 1
  s_cbranch_scc1 L_back_1
  s_cmp_eq_u32 s67, 3
  s_cbranch_scc1 L_back_3
  s_cmp_eq_u32 s67, 5
  s_cbranch_scc1 L_back_5
  s_branch L_end
L_fusion:
  s_getpc_b64 s[32:33]
L_pc:
  s_sub_u32 s32, s32, L_pc-standalone__video_timesformer__vision_kernel
  s_subb_u32 s33, s33, 0
  s_lshl_b32 s31, s3, 5
  v_and_b32 v2, 31, v0
  v_add_u32 v2, s31, v2
  v_lshlrev_b32_e64 v2, 7, v2
  v_min_u32 v3, L_codeend-standalone__video_timesformer__vision_kernel-4, v2
  global_load_dword v255, v3, s[32:33]
  s_waitcnt lgkmcnt(0)
  s_load_dwordx2 s[4:5], s[0:1], 8
  s_mov_b32 s6, 0x00036000
  s_mov_b32 s7, 0x20000
  s_load_dwordx2 s[20:21], s[0:1], 16
  s_mov_b32 s22, 0x00012000
  s_mov_b32 s23, 0x20000
  s_load_dwordx2 s[8:9], s[0:1], 24
  s_mov_b32 s10, 0x00036000
  s_mov_b32 s11, 0x20000
  s_load_dwordx2 s[12:13], s[0:1], 32
  s_mov_b32 s14, 0x00012000
  s_mov_b32 s15, 0x20000
  s_load_dwordx2 s[24:25], s[0:1], 48
  s_mov_b32 s26, 0x00000100
  s_mov_b32 s27, 0x20000
  s_load_dwordx2 s[16:17], s[0:1], 56
  s_mov_b32 s18, 0x00500000
  s_mov_b32 s19, 0x20000
  v_and_b32 v1, 63, v0
  v_lshrrev_b32 v5, 6, v0
  v_lshlrev_b32 v2, 7, v0
  s_lshl_b32 s31, s3, 15
  v_readfirstlane_b32 s28, v5
  v_add_u32_e64 v2, s31, v2
  v_subrev_u32 v3, 221184, v2
  s_lshl_b32 s34, s3, 3
  s_add_u32 s34, s34, s30
  s_cmp_lt_u32 s34, 36
  s_cselect_b32 s36, 1, 0
  s_cselect_b32 s31, 0, 36
  s_sub_u32 s35, s34, s31
  s_mul_i32 s37, s35, 43691
  s_lshr_b32 s37, s37, 17
  s_mul_i32 s38, s37, 3
  s_sub_u32 s38, s35, s38
  s_mov_b32 s49, 1152
  v_lshl_add_u32 v9, s28, 6, v1
  v_mul_u32_u24 v10, 2731, v9
  v_lshrrev_b32 v10, 16, v10
  v_mul_u32_u24 v11, 24, v10
  v_sub_u32 v11, v9, v11
  v_xor_b32 v12, v11, v10
  v_and_b32 v12, 7, v12
  v_and_b32 v11, 24, v11
  v_or_b32 v11, v11, v12
  v_lshlrev_b32_e64 v11, 4, v11
  v_mad_u32_u24 v16, v10, s49, v11
  v_add_u32 v9, 256, v9
  v_mul_u32_u24 v10, 2731, v9
  v_lshrrev_b32 v10, 16, v10
  v_mul_u32_u24 v11, 24, v10
  v_sub_u32 v11, v9, v11
  v_xor_b32 v12, v11, v10
  v_and_b32 v12, 7, v12
  v_and_b32 v11, 24, v11
  v_or_b32 v11, v11, v12
  v_lshlrev_b32 v11, 4, v11
  v_mad_u32_u24 v17, v10, s49, v11
  s_mul_i32 s39, s37, 18432
  s_mul_i32 s40, s36, 768
  s_add_u32 s39, s39, s40
  s_cmp_eq_u32 s36, 1
  s_cbranch_scc1 L_fus_vo_addr
  v_add_u32 v9, 0, v1
  v_mul_u32_u24 v10, 2731, v9
  v_lshrrev_b32 v10, 16, v10
  v_mul_u32_u24 v11, 24, v10
  v_sub_u32 v11, v9, v11
  v_xor_b32 v12, v11, v10
  v_and_b32 v12, 7, v12
  v_and_b32 v11, 24, v11
  v_or_b32 v11, v11, v12
  v_lshlrev_b32 v11, 4, v11
  v_mad_u32_u24 v18, v10, s49, v11
  v_add_u32_e64 v9, 64, v1
  v_mul_u32_u24 v10, 2731, v9
  v_lshrrev_b32 v10, 16, v10
  v_mul_u32_u24 v11, 24, v10
  v_sub_u32 v11, v9, v11
  v_xor_b32 v12, v11, v10
  v_and_b32 v12, 7, v12
  v_and_b32 v11, 24, v11
  v_or_b32 v11, v11, v12
  v_lshlrev_b32 v11, 4, v11
  v_mad_u32_u24 v19, v10, s49, v11
  v_add_u32 v9, 128, v1
  v_mul_u32_u24 v10, 2731, v9
  v_lshrrev_b32 v10, 16, v10
  v_mul_u32_u24 v11, 24, v10
  v_sub_u32 v11, v9, v11
  v_xor_b32 v12, v11, v10
  v_and_b32 v12, 7, v12
  v_and_b32 v11, 24, v11
  v_or_b32 v11, v11, v12
  v_lshlrev_b32 v11, 4, v11
  v_mad_u32_u24 v20, v10, s49, v11
  v_add_u32 v9, 192, v1
  v_mul_u32_u24 v10, 2731, v9
  v_lshrrev_b32 v10, 16, v10
  v_mul_u32_u24 v11, 24, v10
  v_sub_u32 v11, v9, v11
  v_xor_b32 v12, v11, v10
  v_and_b32 v12, 7, v12
  v_and_b32 v11, 24, v11
  v_or_b32 v11, v11, v12
  v_lshlrev_b32 v11, 4, v11
  v_mad_u32_u24 v21, v10, s49, v11
  v_add_u32 v9, 256, v1
  v_mul_u32_u24 v10, 2731, v9
  v_lshrrev_b32 v10, 16, v10
  v_mul_u32_u24 v11, 24, v10
  v_sub_u32 v11, v9, v11
  v_xor_b32 v12, v11, v10
  v_and_b32 v12, 7, v12
  v_and_b32 v11, 24, v11
  v_or_b32 v11, v11, v12
  v_lshlrev_b32 v11, 4, v11
  v_mad_u32_u24 v22, v10, s49, v11
  v_add_u32 v9, 320, v1
  v_mul_u32_u24 v10, 2731, v9
  v_lshrrev_b32 v10, 16, v10
  v_mul_u32_u24 v11, 24, v10
  v_sub_u32 v11, v9, v11
  v_xor_b32 v12, v11, v10
  v_and_b32 v12, 7, v12
  v_and_b32 v11, 24, v11
  v_or_b32 v11, v11, v12
  v_lshlrev_b32 v11, 4, v11
  v_mad_u32_u24 v23, v10, s49, v11
  s_lshl_b32 s40, s38, 2
  s_add_u32 s40, s40, s28
  s_mul_i32 s41, s40, 18432
  s_add_u32 s41, s41, 384
  s_branch L_fus_issue
L_fus_vo_addr:
  v_lshrrev_b32 v10, 3, v1
  v_and_b32 v11, 7, v1
  s_mul_i32 s31, s28, 48
  s_add_u32 s31, s31, 0
  v_add_u32 v12, s31, v10
  v_and_b32 v13, 31, v12
  v_and_b32 v14, 12, v13
  v_lshrrev_b32 v15, 4, v13
  v_add_u32 v14, v14, v12
  v_mad_i32_i24 v14, v15, -12, v14
  v_mul_u32_u24 v14, 384, v14
  v_bfe_u32 v15, v13, 1, 2
  v_lshlrev_b32 v15, 1, v15
  v_xor_b32 v15, v15, v11
  v_lshl_add_u32 v18, v15, 4, v14
  s_mul_i32 s31, s28, 48
  s_add_u32 s31, s31, 8
  v_add_u32 v12, s31, v10
  v_and_b32 v13, 31, v12
  v_and_b32 v14, 12, v13
  v_lshrrev_b32 v15, 4, v13
  v_add_u32_e64 v14, v14, v12
  v_mad_i32_i24 v14, v15, -12, v14
  v_mul_u32_u24 v14, 384, v14
  v_bfe_u32 v15, v13, 1, 2
  v_lshlrev_b32 v15, 1, v15
  v_xor_b32 v15, v15, v11
  v_lshl_add_u32 v19, v15, 4, v14
  s_mul_i32 s31, s28, 48
  s_add_u32 s31, s31, 16
  v_add_u32 v12, s31, v10
  v_and_b32 v13, 31, v12
  v_and_b32 v14, 12, v13
  v_lshrrev_b32 v15, 4, v13
  v_add_u32_e64 v14, v14, v12
  v_mad_i32_i24 v14, v15, -12, v14
  v_mul_u32_u24 v14, 384, v14
  v_bfe_u32 v15, v13, 1, 2
  v_lshlrev_b32 v15, 1, v15
  v_xor_b32 v15, v15, v11
  v_lshl_add_u32 v20, v15, 4, v14
  s_mul_i32 s31, s28, 48
  s_add_u32 s31, s31, 24
  v_add_u32 v12, s31, v10
  v_and_b32 v13, 31, v12
  v_and_b32 v14, 12, v13
  v_lshrrev_b32 v15, 4, v13
  v_add_u32_e64 v14, v14, v12
  v_mad_i32_i24 v14, v15, -12, v14
  v_mul_u32_u24 v14, 384, v14
  v_bfe_u32 v15, v13, 1, 2
  v_lshlrev_b32 v15, 1, v15
  v_xor_b32 v15, v15, v11
  v_lshl_add_u32 v21, v15, 4, v14
  s_mul_i32 s31, s28, 48
  s_add_u32 s31, s31, 32
  v_add_u32 v12, s31, v10
  v_and_b32 v13, 31, v12
  v_and_b32 v14, 12, v13
  v_lshrrev_b32 v15, 4, v13
  v_add_u32_e64 v14, v14, v12
  v_mad_i32_i24 v14, v15, -12, v14
  v_mul_u32_u24 v14, 384, v14
  v_bfe_u32 v15, v13, 1, 2
  v_lshlrev_b32 v15, 1, v15
  v_xor_b32 v15, v15, v11
  v_lshl_add_u32 v22, v15, 4, v14
  s_mul_i32 s31, s28, 48
  s_add_u32 s31, s31, 40
  v_add_u32 v12, s31, v10
  v_and_b32 v13, 31, v12
  v_and_b32 v14, 12, v13
  v_lshrrev_b32 v15, 4, v13
  v_add_u32_e64 v14, v14, v12
  v_mad_i32_i24 v14, v15, -12, v14
  v_mul_u32_u24 v14, 384, v14
  v_bfe_u32 v15, v13, 1, 2
  v_lshlrev_b32 v15, 1, v15
  v_xor_b32 v15, v15, v11
  v_lshl_add_u32 v23, v15, 4, v14
  s_lshl_b32 s40, s38, 2
  s_add_u32 s40, s40, s28
  s_lshl_b32 s41, s38, 7
L_fus_issue:
  s_waitcnt lgkmcnt(0)
  buffer_load_dword v40, v2, s[4:7], 0 offen
  buffer_load_dword v41, v3, s[20:23], 0 offen
  s_lshl_b32 s31, s28, 10
  s_add_u32 m0, s31, 0
  s_nop 0
  buffer_load_dwordx4 v16, s[8:11], s39 offen lds
  s_cmp_ge_u32 s28, 2
  s_cbranch_scc1 L_fus_a1
  s_add_u32 m0, s31, 4096
  s_nop 0
  buffer_load_dwordx4 v17, s[8:11], s39 offen lds
L_fus_a1:
  s_mul_i32 s31, s28, 6144
  s_cmp_eq_u32 s36, 1
  s_cbranch_scc1 L_fus_bvo
  s_add_u32 m0, s31, 8192
  s_nop 0
  buffer_load_dwordx4 v18, s[8:11], s41 offen lds
  s_add_u32 m0, s31, 9216
  s_nop 0
  buffer_load_dwordx4 v19, s[8:11], s41 offen lds
  s_add_u32 m0, s31, 10240
  s_nop 0
  buffer_load_dwordx4 v20, s[8:11], s41 offen lds
  s_add_u32 m0, s31, 11264
  s_nop 0
  buffer_load_dwordx4 v21, s[8:11], s41 offen lds
  s_add_u32 m0, s31, 12288
  s_nop 0
  buffer_load_dwordx4 v22, s[8:11], s41 offen lds
  s_add_u32 m0, s31, 13312
  s_nop 0
  buffer_load_dwordx4 v23, s[8:11], s41 offen lds
  s_branch L_fus_wait
L_fus_bvo:
  s_add_u32 m0, s31, 8192
  s_nop 0
  buffer_load_dwordx4 v18, s[12:15], s41 offen lds
  s_add_u32 m0, s31, 9216
  s_nop 0
  buffer_load_dwordx4 v19, s[12:15], s41 offen lds
  s_add_u32 m0, s31, 10240
  s_nop 0
  buffer_load_dwordx4 v20, s[12:15], s41 offen lds
  s_add_u32 m0, s31, 11264
  s_nop 0
  buffer_load_dwordx4 v21, s[12:15], s41 offen lds
  s_add_u32 m0, s31, 12288
  s_nop 0
  buffer_load_dwordx4 v22, s[12:15], s41 offen lds
  s_add_u32 m0, s31, 13312
  s_nop 0
  buffer_load_dwordx4 v23, s[12:15], s41 offen lds
L_fus_wait:
  v_and_b32 v6, 15, v1
  v_lshrrev_b32_e64 v7, 4, v1
  v_mul_u32_u24 v8, 384, v6
  v_xor_b32 v9, v7, v6
  v_and_b32 v9, 7, v9
  v_lshl_add_u32 v26, v9, 4, v8
  v_xor_b32_e64 v9, 4, v9
  v_lshl_add_u32 v27, v9, 4, v8
  s_mul_i32 s46, s40, 6
  s_lshr_b32 s47, s37, 1
  s_add_u32 s46, s46, s47
  s_lshl_b32 s46, s46, 10
  s_and_b32 s47, s37, 1
  s_lshl_b32 s47, s47, 1
  v_lshrrev_b32 v11, 1, v7
  v_add_u32 v11, s47, v11
  v_and_b32_e64 v14, 1, v7
  s_waitcnt vmcnt(0)
  s_barrier
  ds_read_b128 v[44:47], v26 offset:0
  ds_read_b128 v[48:51], v27 offset:0
  ds_read_b128 v[52:55], v26 offset:128
  ds_read_b128 v[56:59], v27 offset:128
  ds_read_b128 v[60:63], v26 offset:256
  ds_read_b128 v[64:67], v27 offset:256
  s_cmp_eq_u32 s36, 1
  s_cbranch_scc1 L_fus_vo
  v_add_u32 v26, s31, v26
  v_add_u32 v27, s31, v27
  ds_read_b128 v[68:71], v26 offset:8192
  ds_read_b128 v[72:75], v27 offset:8192
  ds_read_b128 v[76:79], v26 offset:8320
  ds_read_b128 v[80:83], v27 offset:8320
  ds_read_b128 v[84:87], v26 offset:8448
  ds_read_b128 v[88:91], v27 offset:8448
  v_lshlrev_b32_e64 v12, 1, v11
  v_mov_b32 v13, 0x78
  v_lshrrev_b32 v12, v12, v13
  v_and_b32 v11, 3, v12
  s_mov_b32 s40, 0x3dd53b95
  s_add_u32 s46, s46, 4718592
  s_branch L_fus_mm
L_fus_vo:
  v_lshrrev_b32 v12, 2, v1
  v_bfe_u32 v13, v12, 1, 2
  v_xor_b32 v13, s28, v13
  v_lshlrev_b32 v13, 5, v13
  v_lshl_add_u32 v13, v12, 7, v13
  v_and_b32_e64 v12, 3, v1
  v_lshl_add_u32 v13, v12, 3, v13
  ds_read_b64_tr_b16 v[68:69], v13 offset:8192
  ds_read_b64_tr_b16 v[70:71], v13 offset:10240
  ds_read_b64_tr_b16 v[72:73], v13 offset:12288
  ds_read_b64_tr_b16 v[74:75], v13 offset:14336
  ds_read_b64_tr_b16 v[76:77], v13 offset:16384
  ds_read_b64_tr_b16 v[78:79], v13 offset:18432
  ds_read_b64_tr_b16 v[80:81], v13 offset:20480
  ds_read_b64_tr_b16 v[82:83], v13 offset:22528
  ds_read_b64_tr_b16 v[84:85], v13 offset:24576
  ds_read_b64_tr_b16 v[86:87], v13 offset:26624
  ds_read_b64_tr_b16 v[88:89], v13 offset:28672
  ds_read_b64_tr_b16 v[90:91], v13 offset:30720
  s_mov_b32 s40, 0x3f800000
  s_add_u32 s46, s46, 4849664
L_fus_mm:
  v_lshl_add_u32 v11, v11, 4, v6
  v_lshlrev_b32 v11, 4, v11
  v_lshl_add_u32 v11, v14, 3, v11
  s_waitcnt lgkmcnt(0)
  v_mfma_f32_16x16x32_bf16 v[96:99], v[44:47], v[68:71], 0
  v_mfma_f32_16x16x32_bf16 v[96:99], v[48:51], v[72:75], v[96:99]
  v_mfma_f32_16x16x32_bf16 v[96:99], v[52:55], v[76:79], v[96:99]
  v_mfma_f32_16x16x32_bf16 v[96:99], v[56:59], v[80:83], v[96:99]
  v_mfma_f32_16x16x32_bf16 v[96:99], v[60:63], v[84:87], v[96:99]
  v_mfma_f32_16x16x32_bf16 v[96:99], v[64:67], v[88:91], v[96:99]
  s_nop 7
  v_mul_f32 v96, s40, v96
  v_mul_f32 v97, s40, v97
  v_mul_f32 v98, s40, v98
  v_mul_f32 v99, s40, v99
  v_cvt_pk_bf16_f32 v100, v96, v97
  v_cvt_pk_bf16_f32 v101, v98, v99
  buffer_store_dwordx2 v[100:101], v11, s[16:19], s46 offen sc1
  s_cmp_ge_u32 s34, 8
  s_cbranch_scc1 L_fus_nozero
  v_mov_b32 v104, 0
  v_mov_b32 v105, 0
  v_mov_b32 v106, 0
  v_mov_b32 v107, 0
  v_lshlrev_b32 v12, 4, v0
  s_lshl_b32 s39, s34, 12
  s_add_u32 s39, s39, 4980736
  buffer_store_dwordx4 v[104:107], v12, s[16:19], s39 offen sc1
L_fus_nozero:
  s_waitcnt vmcnt(0)
  s_barrier
  s_cmp_lg_u32 s28, 0
  s_cbranch_scc1 L_end
  v_mov_b32 v12, 0
  v_mov_b32_e64 v13, 1
  s_mov_b64 exec, 1
  buffer_atomic_add v13, v12, s[24:27], 0 offen sc1
  s_branch L_end
L_end:
  s_endpgm
L_codeend:

.section .rodata,"a"
.p2align 6
.amdhsa_kernel standalone__video_timesformer__vision_kernel
  .amdhsa_next_free_vgpr 512
  .amdhsa_next_free_sgpr 102
  .amdhsa_accum_offset 256
  .amdhsa_group_segment_fixed_size 0
  .amdhsa_kernarg_size 64
  .amdhsa_user_sgpr_count 2
  .amdhsa_user_sgpr_kernarg_segment_ptr 1
  .amdhsa_system_sgpr_workgroup_id_x 1
  .amdhsa_float_denorm_mode_32 3
.end_amdhsa_kernel
```
